```python
import torch

def _softmax(x, axis=-1):
    return torch.softmax(x, dim=axis)
def _gelu(x):
    return torch.nn.functional.gelu(x, approximate="tanh")
def _silu(x):
    return torch.nn.functional.silu(x)
def _sigmoid(x):
    return torch.sigmoid(x)
def _layernorm(x, axis=-1, eps=1e-5):
    m = x.mean(dim=axis, keepdim=True)
    v = x.var(dim=axis, keepdim=True, unbiased=False)
    return (x - m) / torch.sqrt(v + eps)
def _scatter_add(tgt, idx, src, axis=0):
    return tgt.clone().index_add_(axis, idx, src)
def _segment_sum(src, seg, n):
    out = torch.zeros((n,) + src.shape[1:], dtype=src.dtype)
    return out.index_add_(0, seg, src)
def _pad(x, pw):
    flat = tuple(v for pair in reversed(pw) for v in pair)
    return torch.nn.functional.pad(x, flat)

kernel_name = 'sequential_preLN__ssm_conv_s4d__swiglu_ffn__prompt'

def setup_inputs():

    _w = (lambda a: (lambda t: t.to(torch.bfloat16) if t.is_floating_point() else t)(torch.as_tensor(a)))
    def _A_setup():
        Bsz, L, D, N = 1, 2048, 640, 192
        return {
            "u": _w((lambda *s: torch.randn(*s, dtype=torch.bfloat16) * 0.05)(Bsz, L, D)),
            "log_A_real": _w((lambda *s: torch.randn(*s, dtype=torch.bfloat16) * 6.4)(D, N) * 0.5),
            "A_imag": _w((lambda *s: torch.randn(*s, dtype=torch.bfloat16) * 0.05)(D, N) * 3.14),
            "C_real": _w((lambda *s: torch.randn(*s, dtype=torch.bfloat16) * 0.05)(D, N) / N ** 0.5),
            "C_imag": _w((lambda *s: torch.randn(*s, dtype=torch.bfloat16) * 0.05)(D, N) / N ** 0.5),
            "log_dt": _w((lambda *s: torch.randn(*s, dtype=torch.bfloat16) * 0.05)(D) * 0.5 - 4.0),
            "D_skip": _w((lambda *s: torch.randn(*s, dtype=torch.bfloat16) * 0.05)(D)),
        }
    _A_in = _A_setup()

    def _B_setup():
        B, S, D, F = 1, 2048, 640, 1536
        return {
            "x": _w((lambda *s: torch.randn(*s, dtype=torch.bfloat16) * 0.05)(B, S, D)),
            "w_gate": _w((lambda *s: torch.randn(*s, dtype=torch.bfloat16) * 0.05)(D, F)),
            "w_up": _w((lambda *s: torch.randn(*s, dtype=torch.bfloat16) * 0.05)(D, F)),
            "w_down": _w((lambda *s: torch.randn(*s, dtype=torch.bfloat16) * 0.05)(F, D)),
        }
    _B_in = _B_setup()

    return {
        "A_u": _A_in["u"],
        "A_log_A_real": _A_in["log_A_real"],
        "A_A_imag": _A_in["A_imag"],
        "A_C_real": _A_in["C_real"],
        "A_C_imag": _A_in["C_imag"],
        "A_log_dt": _A_in["log_dt"],
        "A_D_skip": _A_in["D_skip"],
        "B_x": _B_in["x"],
        "B_w_gate": _B_in["w_gate"],
        "B_w_up": _B_in["w_up"],
        "B_w_down": _B_in["w_down"],
    }

def reference(A_u, A_log_A_real, A_A_imag, A_C_real, A_C_imag, A_log_dt, A_D_skip, B_x, B_w_gate, B_w_up, B_w_down):
    def _A_ref(u, log_A_real, A_imag, C_real, C_imag, log_dt, D_skip):
        L = u.shape[1]
        dt = torch.exp(log_dt)
        A = -torch.exp(log_A_real) + 1j * A_imag
        C = (C_real + 1j * C_imag) * dt[:, None]
        pos = (lambda x, dt: x.to(dt))(torch.arange(L), log_dt.dtype)
        P = torch.exp((A * dt[:, None])[:, :, None] * pos[None, None, :])
        K = 2.0 * torch.einsum("dn,dnl->dl", C, P).real
        L2 = 2 * L
        u_t = (lambda x, *d: x.permute(*d))(u, 0, 2, 1)
        Kf = (lambda x, *a, **k: torch.fft.rfft(x.float(), *a, **k))(K, L2)
        Uf = (lambda x, *a, **k: torch.fft.rfft(x.float(), *a, **k))(u_t, L2)
        y = (lambda x, *a, **k: torch.fft.irfft(x, *a, **k).to(torch.bfloat16))(Uf * Kf[None, :, :], L2)[:, :, :L]
        y = (lambda x, *d: x.permute(*d))(y, 0, 2, 1)
        return y + u * D_skip[None, None, :]

    def _B_ref(x, w_gate, w_up, w_down):
        g = _silu(x @ w_gate)
        u = x @ w_up
        return (g * u) @ w_down

    x = A_u
    h = x + _A_ref(_layernorm(x, axis=-1), A_log_A_real, A_A_imag, A_C_real, A_C_imag, A_log_dt, A_D_skip)
    h2 = h + _B_ref(_layernorm(h, axis=-1), B_w_gate, B_w_up, B_w_down)
    return h2
```

```asm
; @launch grid=(256,1,1) block=(512,1,1) lds=158784
.amdgcn_target "amdgcn-amd-amdhsa--gfx950"
.text
.globl sequential_preLN__ssm_conv_s4d__swiglu_ffn__prompt_kernel
.p2align 8
.type sequential_preLN__ssm_conv_s4d__swiglu_ffn__prompt_kernel,@function
sequential_preLN__ssm_conv_s4d__swiglu_ffn__prompt_kernel:
    s_getpc_b64 s[16:17]
    s_cmp_ge_u32 s2, 256
    s_cbranch_scc1 L_exit_2
    s_load_dwordx16 s[28:43], s[0:1], 0
    s_load_dwordx8 s[44:51], s[0:1], 64
    s_load_dwordx2 s[4:5], s[0:1], 104
    v_lshrrev_b32 v2, 6, v0
    v_and_b32 v1, 63, v0
    s_and_b32 s24, s2, 7
    s_lshr_b32 s25, s2, 3
    v_readfirstlane_b32 s20, v2
    s_and_b32 s21, s24, 1
    s_lshl_b32 s21, s21, 3
    s_and_b32 s26, s25, 7
    s_add_u32 s21, s21, s26
    s_lshr_b32 s22, s24, 1
    s_lshl_b32 s22, s22, 2
    s_lshr_b32 s26, s25, 3
    s_add_u32 s22, s22, s26
    s_and_b32 s23, s20, 3
    s_sub_u32 s19, s2, 160
    s_lshl_b32 s98, s24, 2
    s_lshr_b32 s26, s25, 3
    s_add_u32 s98, s98, s26
    s_and_b32 s99, s25, 7
    s_cmp_lg_u32 s20, 7
    s_cbranch_scc1 L_nz_8
    v_lshlrev_b32 v2, 2, v1
    v_and_b32 v2, 63, v2
    v_add_u32 v2, 158720, v2
    v_mov_b32 v3, 0
    ds_write_b32 v2, v3
L_nz_8:
    s_waitcnt lgkmcnt(0)
    s_mov_b32 s6, s50
    s_mov_b32 s7, s51
    s_cmp_lt_u32 s20, 4
    s_cbranch_scc1 L_cons_10
    s_cmp_lt_u32 s25, 16
    s_cbranch_scc1 L_help_3
    s_sub_u32 s26, s2, 32
    s_cmp_ge_u32 s25, 20
    s_cselect_b32 s19, s19, s26
    s_cselect_b32 s53, 0, 62464
    s_setprio 2
    v_lshrrev_b32 v2, 2, v1
    v_mul_u32_u24 v3, 1280, v2
    v_and_b32 v4, 3, v1
    v_lshl_add_u32 v3, v4, 4, v3
    s_mul_i32 s26, s19, 20480
    s_mul_i32 s27, s23, 320
    s_add_u32 s27, s27, s26
    s_mul_i32 s52, s23, 5120
    s_add_u32 s26, s26, s52
    s_add_u32 s52, s52, s53
    s_load_dword s18, s[4:5], 0
    s_mov_b32 s8, s28
    s_and_b32 s9, s29, 0xffff
    s_mov_b32 s10, 2621440
    s_mov_b32 s11, 0x20000
    s_cmp_ge_u32 s25, 20
    s_cbranch_scc1 L_lnb_11
    s_barrier
L_lnb_11:
    s_add_u32 m0, s52, 0
    s_nop 0
    buffer_load_dwordx4 v3, s[8:11], s27 offen offset:0 nt lds
    s_add_u32 m0, s52, 960
    s_nop 0
    buffer_load_dwordx4 v3, s[8:11], s27 offen offset:64 nt lds
    s_add_u32 m0, s52, 1920
    s_nop 0
    buffer_load_dwordx4 v3, s[8:11], s27 offen offset:128 nt lds
    s_add_u32 m0, s52, 2880
    s_nop 0
    buffer_load_dwordx4 v3, s[8:11], s27 offen offset:192 nt lds
    s_add_u32 m0, s52, 3840
    s_nop 0
    buffer_load_dwordx4 v3, s[8:11], s27 offen offset:256 nt lds
    s_cmp_lt_u32 s25, 20
    s_cbranch_scc1 L_lnb_12
    s_barrier
L_lnb_12:
    s_branch L_lnrest_9
L_cons_10:
    s_cmp_ge_u32 s25, 20
    s_cbranch_scc1 L_noconv_4
    s_mul_i32 s26, s24, 20
    s_add_u32 s26, s26, s25
    s_lshl_b32 s27, s26, 2
    s_add_u32 s27, s27, s20
    s_mul_i32 s42, s27, 384
    v_lshl_add_u32 v9, v1, 1, s42
    s_lshl_b32 s42, s27, 1
    s_and_b32 s42, s42, 0xfffffffc
    s_mul_i32 m0, s20, 8704
    s_waitcnt lgkmcnt(0)
    s_load_dword s18, s[4:5], 0
    s_load_dword s43, s[38:39], s42
    s_load_dword s52, s[40:41], s42
    s_mov_b32 s8, s30
    s_and_b32 s9, s31, 0xffff
    s_mov_b32 s10, 245760
    s_mov_b32 s11, 0x20000
    buffer_load_ushort v112, v9, s[8:11], 0 offen offset:0 nt
    buffer_load_ushort v116, v9, s[8:11], 0 offen offset:128 nt
    buffer_load_ushort v120, v9, s[8:11], 0 offen offset:256 nt
    s_mov_b32 s8, s32
    s_and_b32 s9, s33, 0xffff
    s_mov_b32 s10, 245760
    s_mov_b32 s11, 0x20000
    buffer_load_ushort v113, v9, s[8:11], 0 offen offset:0 nt
    buffer_load_ushort v117, v9, s[8:11], 0 offen offset:128 nt
    buffer_load_ushort v121, v9, s[8:11], 0 offen offset:256 nt
    s_mov_b32 s8, s34
    s_and_b32 s9, s35, 0xffff
    s_mov_b32 s10, 245760
    s_mov_b32 s11, 0x20000
    buffer_load_ushort v114, v9, s[8:11], 0 offen offset:0 nt
    buffer_load_ushort v118, v9, s[8:11], 0 offen offset:128 nt
    buffer_load_ushort v122, v9, s[8:11], 0 offen offset:256 nt
    s_mov_b32 s8, s36
    s_and_b32 s9, s37, 0xffff
    s_mov_b32 s10, 245760
    s_mov_b32 s11, 0x20000
    buffer_load_ushort v115, v9, s[8:11], 0 offen offset:0 nt
    buffer_load_ushort v119, v9, s[8:11], 0 offen offset:128 nt
    buffer_load_ushort v123, v9, s[8:11], 0 offen offset:256 nt
    s_barrier
    s_mov_b32 s8, s4
    s_and_b32 s9, s5, 0xffff
    s_mov_b32 s10, 268435456
    s_mov_b32 s11, 0x20000
    v_and_b32 v60, 31, v1
    v_mul_u32_u24 v60, 272, v60
    v_lshrrev_b32 v61, 5, v1
    v_lshl_add_u32 v60, v61, 4, v60
    v_add_u32 v60, m0, v60
    s_and_b32 s42, s27, 1
    s_lshl_b32 s42, s42, 4
    s_mul_i32 s31, s20, 8768
    s_add_u32 s31, s31, 86016
    v_mov_b32 v12, 0
    v_mov_b32 v13, 0
    v_lshlrev_b32 v8, 3, v0
    v_add_u32 v8, 121088, v8
    ds_write_b64 v8, v[12:13]
    v_mov_b32 v96, 0
    v_mov_b32 v97, 0
    v_mov_b32 v98, 0
    v_mov_b32 v99, 0
    v_mov_b32 v100, 0
    v_mov_b32 v101, 0
    v_mov_b32 v102, 0
    v_mov_b32 v103, 0
    v_mov_b32 v104, 0
    v_mov_b32 v105, 0
    v_mov_b32 v106, 0
    v_mov_b32 v107, 0
    v_mov_b32 v108, 0
    v_mov_b32 v109, 0
    v_mov_b32 v110, 0
    v_mov_b32 v111, 0
    s_waitcnt lgkmcnt(0)
    s_add_u32 s18, s18, 1
    s_lshr_b32 s43, s43, s42
    s_lshl_b32 s43, s43, 16
    s_lshr_b32 s34, s52, s42
    s_lshl_b32 s34, s34, 16
    v_mov_b32 v6, s43
    v_mul_f32 v6, 0x3fb8aa3b, v6
    v_exp_f32 v6, v6
    v_mov_b32 v138, 0x3f80
    v_cvt_pk_bf16_f32 v6, v6, v6
    v_lshlrev_b32 v6, 16, v6
    v_add_f32 v139, v6, v6
    s_mov_b32 s42, 3
    s_waitcnt vmcnt(0)
L_kg_13:
    v_lshlrev_b32 v2, 16, v112
    v_lshlrev_b32 v3, 16, v113
    v_mul_f32 v2, 0x3fb8aa3b, v2
    v_mul_f32 v8, v3, v6
    v_exp_f32 v2, v2
    v_mul_f32 v8, 0.15915494, v8
    v_lshlrev_b32 v4, 16, v114
    v_cvt_pk_bf16_f32 v2, v2, v2
    v_lshlrev_b32 v5, 16, v115
    v_lshlrev_b32 v2, 16, v2
    v_mul_f32 v22, v4, v139
    v_mul_f32 v7, v2, v6
    v_mul_f32 v23, -v5, v139
    v_mul_f32 v7, 0xbfb8aa3b, v7
    ds_write_addtid_b32 v138 offset:0
    v_mul_f32 v32, 0x41000000, v7
    v_exp_f32 v34, v7
    v_mul_f32 v36, 0x43800000, v7
    v_mul_f32 v33, 0x41000000, v8
    v_fract_f32 v35, v8
    v_mul_f32 v37, 0x43800000, v8
    v_exp_f32 v32, v32
    v_cos_f32 v10, v35
    v_exp_f32 v36, v36
    v_fract_f32 v33, v33
    v_sin_f32 v11, v35
    v_fract_f32 v37, v37
    v_cos_f32 v12, v33
    v_mul_f32 v10, v10, v34
    v_cos_f32 v14, v37
    v_sin_f32 v13, v33
    v_mul_f32 v11, v11, v34
    v_sin_f32 v15, v37
    v_mul_f32 v12, v12, v32
    v_mul_f32 v14, v14, v36
    v_mul_f32 v13, v13, v32
    v_mul_f32 v15, v15, v36
    v_pk_mul_f32 v[20:21], v[12:13], v[12:13] op_sel:[0,0] op_sel_hi:[0,1]
    v_pk_mul_f32 v[16:17], v[10:11], v[10:11] op_sel:[0,0] op_sel_hi:[0,1]
    v_mov_b32 v112, v116
    v_pk_fma_f32 v[20:21], v[12:13], v[12:13], v[20:21] op_sel:[1,1,0] op_sel_hi:[1,0,1] neg_lo:[0,1,0]
    v_pk_fma_f32 v[16:17], v[10:11], v[10:11], v[16:17] op_sel:[1,1,0] op_sel_hi:[1,0,1] neg_lo:[0,1,0]
    v_mov_b32 v113, v117
    v_mov_b32 v114, v118
    v_mov_b32 v115, v119
    v_pk_mul_f32 v[18:19], v[16:17], v[16:17] op_sel:[0,0] op_sel_hi:[0,1]
    v_mov_b32 v116, v120
    v_pk_fma_f32 v[18:19], v[16:17], v[16:17], v[18:19] op_sel:[1,1,0] op_sel_hi:[1,0,1] neg_lo:[0,1,0]
    v_mov_b32 v117, v121
    v_mov_b32 v118, v122
    v_mov_b32 v119, v123
    v_cvt_pk_bf16_f32 v56, v12, v13
    v_cvt_pk_bf16_f32 v57, v20, v21
    v_pk_mul_f32 v[124:125], v[22:23], v[14:15] op_sel:[0,0] op_sel_hi:[0,1] neg_hi:[0,1]
    ds_write_addtid_b32 v56 offset:272
    ds_write_addtid_b32 v57 offset:544
    v_pk_fma_f32 v[124:125], v[22:23], v[14:15], v[124:125] op_sel:[1,1,0] op_sel_hi:[1,0,1]
    v_pk_mul_f32 v[24:25], v[12:13], v[20:21] op_sel:[0,0] op_sel_hi:[0,1]
    v_pk_mul_f32 v[28:29], v[20:21], v[20:21] op_sel:[0,0] op_sel_hi:[0,1]
    v_pk_mul_f32 v[126:127], v[124:125], v[14:15] op_sel:[0,0] op_sel_hi:[0,1] neg_hi:[0,1]
    v_pk_fma_f32 v[24:25], v[12:13], v[20:21], v[24:25] op_sel:[1,1,0] op_sel_hi:[1,0,1] neg_lo:[0,1,0]
    v_pk_fma_f32 v[28:29], v[20:21], v[20:21], v[28:29] op_sel:[1,1,0] op_sel_hi:[1,0,1] neg_lo:[0,1,0]
    v_pk_fma_f32 v[126:127], v[124:125], v[14:15], v[126:127] op_sel:[1,1,0] op_sel_hi:[1,0,1]
    v_cvt_pk_bf16_f32 v56, v24, v25
    v_cvt_pk_bf16_f32 v57, v28, v29
    v_pk_mul_f32 v[128:129], v[126:127], v[14:15] op_sel:[0,0] op_sel_hi:[0,1] neg_hi:[0,1]
    ds_write_addtid_b32 v56 offset:816
    ds_write_addtid_b32 v57 offset:1088
    v_pk_fma_f32 v[128:129], v[126:127], v[14:15], v[128:129] op_sel:[1,1,0] op_sel_hi:[1,0,1]
    v_pk_mul_f32 v[26:27], v[24:25], v[20:21] op_sel:[0,0] op_sel_hi:[0,1]
    v_pk_mul_f32 v[32:33], v[28:29], v[20:21] op_sel:[0,0] op_sel_hi:[0,1]
    v_pk_mul_f32 v[130:131], v[128:129], v[14:15] op_sel:[0,0] op_sel_hi:[0,1] neg_hi:[0,1]
    v_pk_fma_f32 v[26:27], v[24:25], v[20:21], v[26:27] op_sel:[1,1,0] op_sel_hi:[1,0,1] neg_lo:[0,1,0]
    v_pk_fma_f32 v[32:33], v[28:29], v[20:21], v[32:33] op_sel:[1,1,0] op_sel_hi:[1,0,1] neg_lo:[0,1,0]
    v_pk_fma_f32 v[130:131], v[128:129], v[14:15], v[130:131] op_sel:[1,1,0] op_sel_hi:[1,0,1]
    v_cvt_pk_bf16_f32 v56, v26, v27
    v_cvt_pk_bf16_f32 v57, v32, v33
    v_pk_mul_f32 v[132:133], v[130:131], v[14:15] op_sel:[0,0] op_sel_hi:[0,1] neg_hi:[0,1]
    ds_write_addtid_b32 v56 offset:1360
    ds_write_addtid_b32 v57 offset:1632
    v_pk_fma_f32 v[132:133], v[130:131], v[14:15], v[132:133] op_sel:[1,1,0] op_sel_hi:[1,0,1]
    v_pk_mul_f32 v[24:25], v[26:27], v[20:21] op_sel:[0,0] op_sel_hi:[0,1]
    v_pk_mul_f32 v[28:29], v[32:33], v[20:21] op_sel:[0,0] op_sel_hi:[0,1]
    v_pk_mul_f32 v[134:135], v[132:133], v[14:15] op_sel:[0,0] op_sel_hi:[0,1] neg_hi:[0,1]
    v_pk_fma_f32 v[24:25], v[26:27], v[20:21], v[24:25] op_sel:[1,1,0] op_sel_hi:[1,0,1] neg_lo:[0,1,0]
    v_pk_fma_f32 v[28:29], v[32:33], v[20:21], v[28:29] op_sel:[1,1,0] op_sel_hi:[1,0,1] neg_lo:[0,1,0]
    v_pk_fma_f32 v[134:135], v[132:133], v[14:15], v[134:135] op_sel:[1,1,0] op_sel_hi:[1,0,1]
    v_cvt_pk_bf16_f32 v56, v24, v25
    v_cvt_pk_bf16_f32 v57, v28, v29
    v_pk_mul_f32 v[136:137], v[134:135], v[14:15] op_sel:[0,0] op_sel_hi:[0,1] neg_hi:[0,1]
    ds_write_addtid_b32 v56 offset:1904
    ds_write_addtid_b32 v57 offset:2176
    v_pk_fma_f32 v[136:137], v[134:135], v[14:15], v[136:137] op_sel:[1,1,0] op_sel_hi:[1,0,1]
    v_pk_mul_f32 v[26:27], v[24:25], v[20:21] op_sel:[0,0] op_sel_hi:[0,1]
    v_pk_mul_f32 v[32:33], v[28:29], v[20:21] op_sel:[0,0] op_sel_hi:[0,1]
    v_pk_fma_f32 v[26:27], v[24:25], v[20:21], v[26:27] op_sel:[1,1,0] op_sel_hi:[1,0,1] neg_lo:[0,1,0]
    v_pk_fma_f32 v[32:33], v[28:29], v[20:21], v[32:33] op_sel:[1,1,0] op_sel_hi:[1,0,1] neg_lo:[0,1,0]
    v_cvt_pk_bf16_f32 v56, v26, v27
    v_cvt_pk_bf16_f32 v57, v32, v33
    ds_write_addtid_b32 v56 offset:2448
    ds_write_addtid_b32 v57 offset:2720
    v_pk_mul_f32 v[24:25], v[26:27], v[20:21] op_sel:[0,0] op_sel_hi:[0,1]
    v_pk_mul_f32 v[28:29], v[32:33], v[20:21] op_sel:[0,0] op_sel_hi:[0,1]
    v_pk_fma_f32 v[24:25], v[26:27], v[20:21], v[24:25] op_sel:[1,1,0] op_sel_hi:[1,0,1] neg_lo:[0,1,0]
    v_pk_fma_f32 v[28:29], v[32:33], v[20:21], v[28:29] op_sel:[1,1,0] op_sel_hi:[1,0,1] neg_lo:[0,1,0]
    v_cvt_pk_bf16_f32 v56, v24, v25
    v_cvt_pk_bf16_f32 v57, v28, v29
    ds_write_addtid_b32 v56 offset:2992
    ds_write_addtid_b32 v57 offset:3264
    v_pk_mul_f32 v[26:27], v[24:25], v[20:21] op_sel:[0,0] op_sel_hi:[0,1]
    v_pk_mul_f32 v[32:33], v[28:29], v[20:21] op_sel:[0,0] op_sel_hi:[0,1]
    v_pk_fma_f32 v[26:27], v[24:25], v[20:21], v[26:27] op_sel:[1,1,0] op_sel_hi:[1,0,1] neg_lo:[0,1,0]
    v_pk_fma_f32 v[32:33], v[28:29], v[20:21], v[32:33] op_sel:[1,1,0] op_sel_hi:[1,0,1] neg_lo:[0,1,0]
    v_cvt_pk_bf16_f32 v56, v26, v27
    v_cvt_pk_bf16_f32 v57, v32, v33
    ds_write_addtid_b32 v56 offset:3536
    ds_write_addtid_b32 v57 offset:3808
    v_pk_mul_f32 v[24:25], v[26:27], v[20:21] op_sel:[0,0] op_sel_hi:[0,1]
    v_pk_mul_f32 v[28:29], v[32:33], v[20:21] op_sel:[0,0] op_sel_hi:[0,1]
    v_pk_fma_f32 v[24:25], v[26:27], v[20:21], v[24:25] op_sel:[1,1,0] op_sel_hi:[1,0,1] neg_lo:[0,1,0]
    v_pk_fma_f32 v[28:29], v[32:33], v[20:21], v[28:29] op_sel:[1,1,0] op_sel_hi:[1,0,1] neg_lo:[0,1,0]
    v_cvt_pk_bf16_f32 v56, v24, v25
    v_cvt_pk_bf16_f32 v57, v28, v29
    ds_write_addtid_b32 v56 offset:4080
    ds_write_addtid_b32 v57 offset:4352
    v_pk_mul_f32 v[26:27], v[24:25], v[20:21] op_sel:[0,0] op_sel_hi:[0,1]
    v_pk_mul_f32 v[32:33], v[28:29], v[20:21] op_sel:[0,0] op_sel_hi:[0,1]
    v_pk_fma_f32 v[26:27], v[24:25], v[20:21], v[26:27] op_sel:[1,1,0] op_sel_hi:[1,0,1] neg_lo:[0,1,0]
    v_pk_fma_f32 v[32:33], v[28:29], v[20:21], v[32:33] op_sel:[1,1,0] op_sel_hi:[1,0,1] neg_lo:[0,1,0]
    v_cvt_pk_bf16_f32 v56, v26, v27
    v_cvt_pk_bf16_f32 v57, v32, v33
    ds_write_addtid_b32 v56 offset:4624
    ds_write_addtid_b32 v57 offset:4896
    v_pk_mul_f32 v[24:25], v[26:27], v[20:21] op_sel:[0,0] op_sel_hi:[0,1]
    v_pk_mul_f32 v[28:29], v[32:33], v[20:21] op_sel:[0,0] op_sel_hi:[0,1]
    v_pk_fma_f32 v[24:25], v[26:27], v[20:21], v[24:25] op_sel:[1,1,0] op_sel_hi:[1,0,1] neg_lo:[0,1,0]
    v_pk_fma_f32 v[28:29], v[32:33], v[20:21], v[28:29] op_sel:[1,1,0] op_sel_hi:[1,0,1] neg_lo:[0,1,0]
    v_cvt_pk_bf16_f32 v56, v24, v25
    v_cvt_pk_bf16_f32 v57, v28, v29
    ds_write_addtid_b32 v56 offset:5168
    ds_write_addtid_b32 v57 offset:5440
    v_pk_mul_f32 v[26:27], v[24:25], v[20:21] op_sel:[0,0] op_sel_hi:[0,1]
    v_pk_mul_f32 v[32:33], v[28:29], v[20:21] op_sel:[0,0] op_sel_hi:[0,1]
    v_pk_fma_f32 v[26:27], v[24:25], v[20:21], v[26:27] op_sel:[1,1,0] op_sel_hi:[1,0,1] neg_lo:[0,1,0]
    v_pk_fma_f32 v[32:33], v[28:29], v[20:21], v[32:33] op_sel:[1,1,0] op_sel_hi:[1,0,1] neg_lo:[0,1,0]
    v_cvt_pk_bf16_f32 v56, v26, v27
    v_cvt_pk_bf16_f32 v57, v32, v33
    ds_write_addtid_b32 v56 offset:5712
    ds_write_addtid_b32 v57 offset:5984
    v_pk_mul_f32 v[24:25], v[26:27], v[20:21] op_sel:[0,0] op_sel_hi:[0,1]
    v_pk_mul_f32 v[28:29], v[32:33], v[20:21] op_sel:[0,0] op_sel_hi:[0,1]
    v_pk_fma_f32 v[24:25], v[26:27], v[20:21], v[24:25] op_sel:[1,1,0] op_sel_hi:[1,0,1] neg_lo:[0,1,0]
    v_pk_fma_f32 v[28:29], v[32:33], v[20:21], v[28:29] op_sel:[1,1,0] op_sel_hi:[1,0,1] neg_lo:[0,1,0]
    v_cvt_pk_bf16_f32 v56, v24, v25
    v_cvt_pk_bf16_f32 v57, v28, v29
    ds_write_addtid_b32 v56 offset:6256
    ds_write_addtid_b32 v57 offset:6528
    v_pk_mul_f32 v[26:27], v[24:25], v[20:21] op_sel:[0,0] op_sel_hi:[0,1]
    v_pk_mul_f32 v[32:33], v[28:29], v[20:21] op_sel:[0,0] op_sel_hi:[0,1]
    v_pk_fma_f32 v[26:27], v[24:25], v[20:21], v[26:27] op_sel:[1,1,0] op_sel_hi:[1,0,1] neg_lo:[0,1,0]
    v_pk_fma_f32 v[32:33], v[28:29], v[20:21], v[32:33] op_sel:[1,1,0] op_sel_hi:[1,0,1] neg_lo:[0,1,0]
    v_cvt_pk_bf16_f32 v56, v26, v27
    v_cvt_pk_bf16_f32 v57, v32, v33
    ds_write_addtid_b32 v56 offset:6800
    ds_write_addtid_b32 v57 offset:7072
    v_pk_mul_f32 v[24:25], v[26:27], v[20:21] op_sel:[0,0] op_sel_hi:[0,1]
    v_pk_mul_f32 v[28:29], v[32:33], v[20:21] op_sel:[0,0] op_sel_hi:[0,1]
    v_pk_fma_f32 v[24:25], v[26:27], v[20:21], v[24:25] op_sel:[1,1,0] op_sel_hi:[1,0,1] neg_lo:[0,1,0]
    v_pk_fma_f32 v[28:29], v[32:33], v[20:21], v[28:29] op_sel:[1,1,0] op_sel_hi:[1,0,1] neg_lo:[0,1,0]
    v_cvt_pk_bf16_f32 v56, v24, v25
    v_cvt_pk_bf16_f32 v57, v28, v29
    ds_write_addtid_b32 v56 offset:7344
    ds_write_addtid_b32 v57 offset:7616
    v_pk_mul_f32 v[26:27], v[24:25], v[20:21] op_sel:[0,0] op_sel_hi:[0,1]
    v_pk_mul_f32 v[32:33], v[28:29], v[20:21] op_sel:[0,0] op_sel_hi:[0,1]
    v_pk_fma_f32 v[26:27], v[24:25], v[20:21], v[26:27] op_sel:[1,1,0] op_sel_hi:[1,0,1] neg_lo:[0,1,0]
    v_pk_fma_f32 v[32:33], v[28:29], v[20:21], v[32:33] op_sel:[1,1,0] op_sel_hi:[1,0,1] neg_lo:[0,1,0]
    v_cvt_pk_bf16_f32 v56, v26, v27
    v_cvt_pk_bf16_f32 v57, v32, v33
    ds_write_addtid_b32 v56 offset:7888
    ds_write_addtid_b32 v57 offset:8160
    v_pk_mul_f32 v[24:25], v[26:27], v[20:21] op_sel:[0,0] op_sel_hi:[0,1]
    v_pk_fma_f32 v[24:25], v[26:27], v[20:21], v[24:25] op_sel:[1,1,0] op_sel_hi:[1,0,1] neg_lo:[0,1,0]
    v_cvt_pk_bf16_f32 v56, v24, v25
    ds_write_addtid_b32 v56 offset:8432
    ds_read_b128 v[64:67], v60 offset:0
    ds_read_b128 v[68:71], v60 offset:32
    ds_read_b128 v[72:75], v60 offset:64
    ds_read_b128 v[76:79], v60 offset:96
    ds_read_b128 v[80:83], v60 offset:128
    ds_read_b128 v[84:87], v60 offset:160
    ds_read_b128 v[88:91], v60 offset:192
    ds_read_b128 v[92:95], v60 offset:224
    v_cvt_pk_bf16_f32 v56, v22, v23
    v_cvt_pk_bf16_f32 v57, v124, v125
    v_cvt_pk_bf16_f32 v58, v126, v127
    v_cvt_pk_bf16_f32 v62, v130, v131
    ds_write_addtid_b32 v56 offset:0
    ds_write_addtid_b32 v57 offset:1088
    ds_write_addtid_b32 v58 offset:4624
    ds_write_addtid_b32 v62 offset:6528
    v_pk_mul_f32 v[24:25], v[22:23], v[10:11] op_sel:[0,0] op_sel_hi:[0,1] neg_hi:[0,1]
    ds_write_addtid_b32 v57 offset:1360
    v_pk_mul_f32 v[48:49], v[126:127], v[18:19] op_sel:[0,0] op_sel_hi:[0,1] neg_hi:[0,1]
    v_pk_mul_f32 v[52:53], v[130:131], v[12:13] op_sel:[0,0] op_sel_hi:[0,1] neg_hi:[0,1]
    v_pk_fma_f32 v[24:25], v[22:23], v[10:11], v[24:25] op_sel:[1,1,0] op_sel_hi:[1,0,1]
    v_pk_mul_f32 v[44:45], v[124:125], v[16:17] op_sel:[0,0] op_sel_hi:[0,1] neg_hi:[0,1]
    v_pk_fma_f32 v[48:49], v[126:127], v[18:19], v[48:49] op_sel:[1,1,0] op_sel_hi:[1,0,1]
    v_pk_fma_f32 v[52:53], v[130:131], v[12:13], v[52:53] op_sel:[1,1,0] op_sel_hi:[1,0,1]
    v_cvt_pk_bf16_f32 v56, v24, v25
    v_pk_fma_f32 v[44:45], v[124:125], v[16:17], v[44:45] op_sel:[1,1,0] op_sel_hi:[1,0,1]
    v_pk_mul_f32 v[50:51], v[126:127], v[12:13] op_sel:[0,0] op_sel_hi:[0,1] neg_hi:[0,1]
    v_cvt_pk_bf16_f32 v63, v52, v53
    ds_write_addtid_b32 v56 offset:272
    v_cvt_pk_bf16_f32 v57, v44, v45
    v_pk_fma_f32 v[50:51], v[126:127], v[12:13], v[50:51] op_sel:[1,1,0] op_sel_hi:[1,0,1]
    ds_write_addtid_b32 v63 offset:6800
    v_pk_mul_f32 v[26:27], v[24:25], v[10:11] op_sel:[0,0] op_sel_hi:[0,1] neg_hi:[0,1]
    ds_write_addtid_b32 v57 offset:1632
    v_cvt_pk_bf16_f32 v59, v48, v49
    v_cvt_pk_bf16_f32 v62, v132, v133
    v_pk_fma_f32 v[26:27], v[24:25], v[10:11], v[26:27] op_sel:[1,1,0] op_sel_hi:[1,0,1]
    v_pk_mul_f32 v[46:47], v[44:45], v[16:17] op_sel:[0,0] op_sel_hi:[0,1] neg_hi:[0,1]
    ds_write_addtid_b32 v59 offset:4896
    ds_write_addtid_b32 v62 offset:7616
    v_cvt_pk_bf16_f32 v56, v26, v27
    v_pk_fma_f32 v[46:47], v[44:45], v[16:17], v[46:47] op_sel:[1,1,0] op_sel_hi:[1,0,1]
    v_cvt_pk_bf16_f32 v58, v50, v51
    v_pk_mul_f32 v[52:53], v[132:133], v[12:13] op_sel:[0,0] op_sel_hi:[0,1] neg_hi:[0,1]
    ds_write_addtid_b32 v56 offset:544
    v_cvt_pk_bf16_f32 v57, v46, v47
    ds_write_addtid_b32 v58 offset:5168
    v_pk_fma_f32 v[52:53], v[132:133], v[12:13], v[52:53] op_sel:[1,1,0] op_sel_hi:[1,0,1]
    v_pk_mul_f32 v[24:25], v[26:27], v[10:11] op_sel:[0,0] op_sel_hi:[0,1] neg_hi:[0,1]
    ds_write_addtid_b32 v57 offset:1904
    v_cvt_pk_bf16_f32 v58, v128, v129
    v_cvt_pk_bf16_f32 v63, v52, v53
    v_pk_fma_f32 v[24:25], v[26:27], v[10:11], v[24:25] op_sel:[1,1,0] op_sel_hi:[1,0,1]
    ds_write_addtid_b32 v57 offset:3264
    ds_write_addtid_b32 v58 offset:5712
    ds_write_addtid_b32 v63 offset:7888
    v_cvt_pk_bf16_f32 v56, v24, v25
    ds_write_addtid_b32 v57 offset:3536
    v_pk_mul_f32 v[48:49], v[128:129], v[18:19] op_sel:[0,0] op_sel_hi:[0,1] neg_hi:[0,1]
    v_cvt_pk_bf16_f32 v62, v134, v135
    ds_write_addtid_b32 v56 offset:816
    v_pk_mul_f32 v[44:45], v[46:47], v[16:17] op_sel:[0,0] op_sel_hi:[0,1] neg_hi:[0,1]
    v_pk_fma_f32 v[48:49], v[128:129], v[18:19], v[48:49] op_sel:[1,1,0] op_sel_hi:[1,0,1]
    ds_write_addtid_b32 v62 offset:7072
    v_pk_mul_f32 v[26:27], v[24:25], v[10:11] op_sel:[0,0] op_sel_hi:[0,1] neg_hi:[0,1]
    v_pk_fma_f32 v[44:45], v[46:47], v[16:17], v[44:45] op_sel:[1,1,0] op_sel_hi:[1,0,1]
    v_pk_mul_f32 v[50:51], v[128:129], v[12:13] op_sel:[0,0] op_sel_hi:[0,1] neg_hi:[0,1]
    v_pk_mul_f32 v[52:53], v[134:135], v[12:13] op_sel:[0,0] op_sel_hi:[0,1] neg_hi:[0,1]
    v_pk_fma_f32 v[26:27], v[24:25], v[10:11], v[26:27] op_sel:[1,1,0] op_sel_hi:[1,0,1]
    v_cvt_pk_bf16_f32 v57, v44, v45
    v_pk_fma_f32 v[50:51], v[128:129], v[12:13], v[50:51] op_sel:[1,1,0] op_sel_hi:[1,0,1]
    v_pk_fma_f32 v[52:53], v[134:135], v[12:13], v[52:53] op_sel:[1,1,0] op_sel_hi:[1,0,1]
    v_cvt_pk_bf16_f32 v56, v26, v27
    ds_write_addtid_b32 v57 offset:3808
    v_cvt_pk_bf16_f32 v59, v48, v49
    v_cvt_pk_bf16_f32 v63, v52, v53
    ds_write_addtid_b32 v56 offset:2176
    v_pk_mul_f32 v[46:47], v[44:45], v[16:17] op_sel:[0,0] op_sel_hi:[0,1] neg_hi:[0,1]
    ds_write_addtid_b32 v59 offset:5984
    ds_write_addtid_b32 v63 offset:7344
    v_pk_mul_f32 v[24:25], v[26:27], v[10:11] op_sel:[0,0] op_sel_hi:[0,1] neg_hi:[0,1]
    v_pk_fma_f32 v[46:47], v[44:45], v[16:17], v[46:47] op_sel:[1,1,0] op_sel_hi:[1,0,1]
    v_cvt_pk_bf16_f32 v58, v50, v51
    v_cvt_pk_bf16_f32 v62, v136, v137
    v_pk_fma_f32 v[24:25], v[26:27], v[10:11], v[24:25] op_sel:[1,1,0] op_sel_hi:[1,0,1]
    v_cvt_pk_bf16_f32 v57, v46, v47
    ds_write_addtid_b32 v58 offset:6256
    ds_write_addtid_b32 v62 offset:8160
    v_cvt_pk_bf16_f32 v56, v24, v25
    ds_write_addtid_b32 v57 offset:4080
    v_pk_mul_f32 v[52:53], v[136:137], v[12:13] op_sel:[0,0] op_sel_hi:[0,1] neg_hi:[0,1]
    ds_write_addtid_b32 v56 offset:2448
    ds_write_addtid_b32 v57 offset:5440
    v_pk_fma_f32 v[52:53], v[136:137], v[12:13], v[52:53] op_sel:[1,1,0] op_sel_hi:[1,0,1]
    v_pk_mul_f32 v[26:27], v[24:25], v[10:11] op_sel:[0,0] op_sel_hi:[0,1] neg_hi:[0,1]
    v_cvt_pk_bf16_f32 v63, v52, v53
    v_pk_fma_f32 v[26:27], v[24:25], v[10:11], v[26:27] op_sel:[1,1,0] op_sel_hi:[1,0,1]
    ds_write_addtid_b32 v63 offset:8432
    v_cvt_pk_bf16_f32 v56, v26, v27
    ds_write_addtid_b32 v56 offset:2720
    v_pk_mul_f32 v[24:25], v[26:27], v[10:11] op_sel:[0,0] op_sel_hi:[0,1] neg_hi:[0,1]
    v_pk_fma_f32 v[24:25], v[26:27], v[10:11], v[24:25] op_sel:[1,1,0] op_sel_hi:[1,0,1]
    v_cvt_pk_bf16_f32 v56, v24, v25
    ds_write_addtid_b32 v56 offset:2992
    v_pk_mul_f32 v[26:27], v[24:25], v[10:11] op_sel:[0,0] op_sel_hi:[0,1] neg_hi:[0,1]
    v_pk_fma_f32 v[26:27], v[24:25], v[10:11], v[26:27] op_sel:[1,1,0] op_sel_hi:[1,0,1]
    v_cvt_pk_bf16_f32 v56, v26, v27
    ds_write_addtid_b32 v56 offset:4352
    ds_read_b128 v[16:19], v60 offset:0
    ds_read_b128 v[20:23], v60 offset:32
    ds_read_b128 v[24:27], v60 offset:64
    ds_read_b128 v[28:31], v60 offset:96
    ds_read_b128 v[32:35], v60 offset:128
    ds_read_b128 v[36:39], v60 offset:160
    ds_read_b128 v[40:43], v60 offset:192
    ds_read_b128 v[44:47], v60 offset:224
    s_waitcnt lgkmcnt(7)
    v_mfma_f32_32x32x16_bf16 v[96:111], v[16:19], v[64:67], v[96:111]
    s_waitcnt lgkmcnt(6)
    v_mfma_f32_32x32x16_bf16 v[96:111], v[20:23], v[68:71], v[96:111]
    s_waitcnt lgkmcnt(5)
    v_mfma_f32_32x32x16_bf16 v[96:111], v[24:27], v[72:75], v[96:111]
    s_waitcnt lgkmcnt(4)
    v_mfma_f32_32x32x16_bf16 v[96:111], v[28:31], v[76:79], v[96:111]
    s_waitcnt lgkmcnt(3)
    v_mfma_f32_32x32x16_bf16 v[96:111], v[32:35], v[80:83], v[96:111]
    s_waitcnt lgkmcnt(2)
    v_mfma_f32_32x32x16_bf16 v[96:111], v[36:39], v[84:87], v[96:111]
    s_waitcnt lgkmcnt(1)
    v_mfma_f32_32x32x16_bf16 v[96:111], v[40:43], v[88:91], v[96:111]
    s_waitcnt lgkmcnt(0)
    v_mfma_f32_32x32x16_bf16 v[96:111], v[44:47], v[92:95], v[96:111]
    v_mov_b32 v2, 158748
    v_mov_b32 v3, 1
    s_mov_b64 exec, 1
    ds_add_u32 v2, v3
    s_mov_b64 exec, -1
    s_sub_u32 s42, s42, 1
    s_cmp_lg_u32 s42, 0
    s_cbranch_scc1 L_kg_13
    v_lshlrev_b32 v2, 4, v1
    v_sub_u32 v2, s31, v2
    v_add_u32 v2, 1008, v2
    v_lshl_add_u32 v3, v1, 2, s31
    v_and_b32 v4, 1, v1
    v_cmp_eq_u32 vcc, 1, v4
    v_mov_b32 v5, 0
    s_nop 0
    v_cndmask_b32 v6, v108, v109, vcc
    v_cndmask_b32 v7, v110, v111, vcc
    v_cvt_pk_bf16_f32 v8, v96, v5
    v_cmp_eq_u32 vcc, 0, v1
    ds_write_b32 v3, v5 offset:4096
    s_nop 0
    v_cndmask_b32 v8, 0, v8, vcc
    ds_write_b32 v3, v8 offset:8512
    v_cvt_pk_bf16_f32 v16, v103, v102
    v_cvt_pk_bf16_f32 v17, v101, v100
    v_cvt_pk_bf16_f32 v18, v99, v98
    v_cvt_pk_bf16_f32 v19, v97, v96
    ds_write_b128 v2, v[16:19] offset:3072
    v_cvt_pk_bf16_f32 v20, v104, v103
    v_cvt_pk_bf16_f32 v21, v102, v101
    v_cvt_pk_bf16_f32 v22, v100, v99
    v_cvt_pk_bf16_f32 v23, v98, v97
    ds_write_b128 v2, v[20:23] offset:7488
    v_cvt_pk_bf16_f32 v24, v107, v107
    v_cvt_pk_bf16_f32 v25, v106, v106
    v_cvt_pk_bf16_f32 v26, v106, v105
    v_cvt_pk_bf16_f32 v27, v105, v105
    ds_write_b128 v2, v[24:27] offset:2048
    v_cvt_pk_bf16_f32 v28, v107, v107
    v_cvt_pk_bf16_f32 v29, v107, v106
    v_cvt_pk_bf16_f32 v30, v106, v106
    v_cvt_pk_bf16_f32 v31, v105, v105
    ds_write_b128 v2, v[28:31] offset:6464
    v_cvt_pk_bf16_f32 v32, v109, v109
    v_cvt_pk_bf16_f32 v33, v109, v6
    v_cvt_pk_bf16_f32 v34, v108, v108
    v_cvt_pk_bf16_f32 v35, v108, v108
    ds_write_b128 v2, v[32:35] offset:1024
    v_cvt_pk_bf16_f32 v36, v109, v109
    v_cvt_pk_bf16_f32 v37, v109, v109
    v_cvt_pk_bf16_f32 v38, v6, v108
    v_cvt_pk_bf16_f32 v39, v108, v108
    ds_write_b128 v2, v[36:39] offset:5440
    v_cvt_pk_bf16_f32 v40, v111, v111
    v_cvt_pk_bf16_f32 v41, v111, v7
    v_cvt_pk_bf16_f32 v42, v110, v110
    v_cvt_pk_bf16_f32 v43, v110, v110
    ds_write_b128 v2, v[40:43] offset:0
    v_cvt_pk_bf16_f32 v44, v111, v111
    v_cvt_pk_bf16_f32 v45, v111, v111
    v_cvt_pk_bf16_f32 v46, v7, v110
    v_cvt_pk_bf16_f32 v47, v110, v110
    ds_write_b128 v2, v[44:47] offset:4416
    v_lshrrev_b32 v10, 4, v1
    v_and_b32 v9, 15, v1
    v_or_b32 v11, 1, v9
    v_sub_u32 v11, 1807, v11
    v_lshlrev_b32 v11, 1, v11
    v_lshl_add_u32 v11, v10, 4, v11
    v_and_b32 v7, 1, v1
    v_xor_b32 v7, 1, v7
    v_mul_u32_u24 v7, 4420, v7
    v_add3_u32 v176, v11, v7, s31
    v_subrev_u32 v177, 512, v176
    v_subrev_u32 v178, 1024, v176
    v_subrev_u32 v179, 1536, v176
    v_subrev_u32 v180, 2048, v176
    v_subrev_u32 v181, 2560, v176
    v_subrev_u32 v182, 3072, v176
    v_subrev_u32 v183, 3584, v176
    v_lshrrev_b32 v11, 1, v10
    v_add_u32 v11, v11, v9
    v_and_b32 v12, 1, v10
    v_lshlrev_b32 v12, 4, v12
    v_add_u32 v13, 7, v11
    v_bfe_u32 v14, v13, 1, 2
    v_xor_b32 v14, s20, v14
    v_lshl_add_u32 v14, v14, 5, v12
    v_lshl_add_u32 v14, v13, 7, v14
    v_add_u32 v184, 121088, v14
    v_add_u32 v13, 5, v11
    v_bfe_u32 v14, v13, 1, 2
    v_xor_b32 v14, s20, v14
    v_lshl_add_u32 v14, v14, 5, v12
    v_lshl_add_u32 v14, v13, 7, v14
    v_add_u32 v185, 121088, v14
    v_add_u32 v13, 3, v11
    v_bfe_u32 v14, v13, 1, 2
    v_xor_b32 v14, s20, v14
    v_lshl_add_u32 v14, v14, 5, v12
    v_lshl_add_u32 v14, v13, 7, v14
    v_add_u32 v186, 121088, v14
    v_add_u32 v13, 1, v11
    v_bfe_u32 v14, v13, 1, 2
    v_xor_b32 v14, s20, v14
    v_lshl_add_u32 v14, v14, 5, v12
    v_lshl_add_u32 v14, v13, 7, v14
    v_add_u32 v187, 121088, v14
    v_bfe_u32 v14, v9, 1, 2
    v_xor_b32 v14, s20, v14
    v_lshlrev_b32 v14, 5, v14
    v_lshl_add_u32 v14, v9, 7, v14
    v_lshl_add_u32 v14, v10, 3, v14
    v_add_u32 v188, 123136, v14
    v_add_u32 v189, 139520, v14
    v_lshlrev_b32 v11, 5, v9
    v_and_b32 v12, 1, v10
    v_lshl_add_u32 v11, v12, 9, v11
    v_lshrrev_b32 v12, 1, v10
    v_lshl_add_u32 v5, v12, 4, v11
    s_lshl_b32 s35, s27, 12
    s_add_u32 s35, s35, 6291456
    s_lshl_b32 s36, s26, 6
    s_add_u32 s36, s36, 16384
    ds_read2_b32 v[48:49], v176 offset0:112 offset1:113
    ds_read2_b32 v[50:51], v176 offset0:114 offset1:115
    ds_read2_b32 v[52:53], v177 offset0:112 offset1:113
    ds_read2_b32 v[54:55], v177 offset0:114 offset1:115
    ds_read2_b32 v[56:57], v178 offset0:112 offset1:113
    ds_read2_b32 v[58:59], v178 offset0:114 offset1:115
    ds_read2_b32 v[60:61], v179 offset0:112 offset1:113
    ds_read2_b32 v[62:63], v179 offset0:114 offset1:115
    ds_read2_b32 v[64:65], v180 offset0:112 offset1:113
    ds_read2_b32 v[66:67], v180 offset0:114 offset1:115
    ds_read2_b32 v[68:69], v181 offset0:112 offset1:113
    ds_read2_b32 v[70:71], v181 offset0:114 offset1:115
    ds_read2_b32 v[72:73], v182 offset0:112 offset1:113
    ds_read2_b32 v[74:75], v182 offset0:114 offset1:115
    ds_read2_b32 v[76:77], v183 offset0:112 offset1:113
    ds_read2_b32 v[78:79], v183 offset0:114 offset1:115
    s_waitcnt lgkmcnt(0)
    s_barrier
    ds_read_b128 v[80:83], v184 offset:1024
    ds_read_b128 v[84:87], v184 offset:3072
    ds_read_b128 v[88:91], v184 offset:5120
    ds_read_b128 v[92:95], v184 offset:7168
    ds_read_b128 v[96:99], v184 offset:9216
    ds_read_b128 v[100:103], v184 offset:11264
    ds_read_b128 v[104:107], v184 offset:13312
    ds_read_b128 v[108:111], v184 offset:15360
    s_waitcnt lgkmcnt(7)
    v_mfma_f32_16x16x32_bf16 v[16:19], v[48:51], v[80:83], 0
    ds_read_b128 v[144:147], v185 offset:1024
    v_mfma_f32_16x16x32_bf16 v[20:23], v[52:55], v[80:83], 0
    ds_read2_b32 v[112:113], v176 offset0:96 offset1:97
    s_waitcnt lgkmcnt(8)
    v_mfma_f32_16x16x32_bf16 v[20:23], v[48:51], v[84:87], v[20:23]
    ds_read2_b32 v[114:115], v176 offset0:98 offset1:99
    v_mfma_f32_16x16x32_bf16 v[24:27], v[52:55], v[84:87], 0
    ds_read_b128 v[148:151], v185 offset:3072
    v_mfma_f32_16x16x32_bf16 v[24:27], v[56:59], v[80:83], v[24:27]
    ds_read2_b32 v[116:117], v177 offset0:96 offset1:97
    s_waitcnt lgkmcnt(10)
    v_mfma_f32_16x16x32_bf16 v[24:27], v[48:51], v[88:91], v[24:27]
    ds_read2_b32 v[118:119], v177 offset0:98 offset1:99
    v_mfma_f32_16x16x32_bf16 v[28:31], v[56:59], v[84:87], 0
    ds_read_b128 v[152:155], v185 offset:5120
    v_mfma_f32_16x16x32_bf16 v[28:31], v[52:55], v[88:91], v[28:31]
    ds_read2_b32 v[120:121], v178 offset0:96 offset1:97
    v_mfma_f32_16x16x32_bf16 v[32:35], v[56:59], v[88:91], 0
    ds_read2_b32 v[122:123], v178 offset0:98 offset1:99
    v_mfma_f32_16x16x32_bf16 v[28:31], v[60:63], v[80:83], v[28:31]
    ds_read_b128 v[156:159], v185 offset:7168
    s_waitcnt lgkmcnt(14)
    v_mfma_f32_16x16x32_bf16 v[28:31], v[48:51], v[92:95], v[28:31]
    ds_read2_b32 v[124:125], v179 offset0:96 offset1:97
    v_mfma_f32_16x16x32_bf16 v[32:35], v[60:63], v[84:87], v[32:35]
    ds_read2_b32 v[126:127], v179 offset0:98 offset1:99
    v_mfma_f32_16x16x32_bf16 v[32:35], v[52:55], v[92:95], v[32:35]
    ds_read_b128 v[160:163], v185 offset:9216
    v_mfma_f32_16x16x32_bf16 v[36:39], v[60:63], v[88:91], 0
    ds_read2_b32 v[128:129], v180 offset0:96 offset1:97
    v_mfma_f32_16x16x32_bf16 v[36:39], v[56:59], v[92:95], v[36:39]
    ds_read2_b32 v[130:131], v180 offset0:98 offset1:99
    v_mfma_f32_16x16x32_bf16 v[40:43], v[60:63], v[92:95], 0
    ds_read_b128 v[164:167], v185 offset:11264
    v_mfma_f32_16x16x32_bf16 v[32:35], v[64:67], v[80:83], v[32:35]
    ds_read2_b32 v[132:133], v181 offset0:96 offset1:97
    s_waitcnt lgkmcnt(15)
    v_mfma_f32_16x16x32_bf16 v[32:35], v[48:51], v[96:99], v[32:35]
    ds_read2_b32 v[134:135], v181 offset0:98 offset1:99
    v_mfma_f32_16x16x32_bf16 v[36:39], v[64:67], v[84:87], v[36:39]
    ds_read_b128 v[168:171], v185 offset:13312
    v_mfma_f32_16x16x32_bf16 v[36:39], v[52:55], v[96:99], v[36:39]
    ds_read2_b32 v[136:137], v182 offset0:96 offset1:97
    v_mfma_f32_16x16x32_bf16 v[40:43], v[64:67], v[88:91], v[40:43]
    ds_read2_b32 v[138:139], v182 offset0:98 offset1:99
    v_mfma_f32_16x16x32_bf16 v[40:43], v[56:59], v[96:99], v[40:43]
    ds_read_b128 v[172:175], v185 offset:15360
    v_mfma_f32_16x16x32_bf16 v[44:47], v[64:67], v[92:95], 0
    ds_read2_b32 v[140:141], v183 offset0:96 offset1:97
    v_mfma_f32_16x16x32_bf16 v[44:47], v[60:63], v[96:99], v[44:47]
    ds_read2_b32 v[142:143], v183 offset0:98 offset1:99
    v_mfma_f32_16x16x32_bf16 v[36:39], v[68:71], v[80:83], v[36:39]
    v_mfma_f32_16x16x32_bf16 v[36:39], v[48:51], v[100:103], v[36:39]
    v_mfma_f32_16x16x32_bf16 v[40:43], v[68:71], v[84:87], v[40:43]
    v_mfma_f32_16x16x32_bf16 v[40:43], v[52:55], v[100:103], v[40:43]
    v_mfma_f32_16x16x32_bf16 v[44:47], v[68:71], v[88:91], v[44:47]
    v_mfma_f32_16x16x32_bf16 v[44:47], v[56:59], v[100:103], v[44:47]
    v_mfma_f32_16x16x32_bf16 v[40:43], v[72:75], v[80:83], v[40:43]
    v_mfma_f32_16x16x32_bf16 v[40:43], v[48:51], v[104:107], v[40:43]
    v_mfma_f32_16x16x32_bf16 v[44:47], v[72:75], v[84:87], v[44:47]
    v_mfma_f32_16x16x32_bf16 v[44:47], v[52:55], v[104:107], v[44:47]
    v_mfma_f32_16x16x32_bf16 v[44:47], v[76:79], v[80:83], v[44:47]
    v_mfma_f32_16x16x32_bf16 v[44:47], v[48:51], v[108:111], v[44:47]
    s_waitcnt lgkmcnt(15)
    v_mfma_f32_16x16x32_bf16 v[16:19], v[112:115], v[144:147], v[16:19]
    ds_read_b128 v[80:83], v186 offset:1024
    v_mfma_f32_16x16x32_bf16 v[20:23], v[116:119], v[144:147], v[20:23]
    ds_read2_b32 v[48:49], v176 offset0:80 offset1:81
    v_mfma_f32_16x16x32_bf16 v[20:23], v[112:115], v[148:151], v[20:23]
    ds_read2_b32 v[50:51], v176 offset0:82 offset1:83
    v_mfma_f32_16x16x32_bf16 v[24:27], v[116:119], v[148:151], v[24:27]
    ds_read_b128 v[84:87], v186 offset:3072
    v_mfma_f32_16x16x32_bf16 v[24:27], v[120:123], v[144:147], v[24:27]
    ds_read2_b32 v[52:53], v177 offset0:80 offset1:81
    v_mfma_f32_16x16x32_bf16 v[24:27], v[112:115], v[152:155], v[24:27]
    ds_read2_b32 v[54:55], v177 offset0:82 offset1:83
    v_mfma_f32_16x16x32_bf16 v[28:31], v[120:123], v[148:151], v[28:31]
    ds_read_b128 v[88:91], v186 offset:5120
    v_mfma_f32_16x16x32_bf16 v[28:31], v[116:119], v[152:155], v[28:31]
    ds_read2_b32 v[56:57], v178 offset0:80 offset1:81
    v_mfma_f32_16x16x32_bf16 v[32:35], v[120:123], v[152:155], v[32:35]
    ds_read2_b32 v[58:59], v178 offset0:82 offset1:83
    s_waitcnt lgkmcnt(15)
    v_mfma_f32_16x16x32_bf16 v[28:31], v[124:127], v[144:147], v[28:31]
    ds_read_b128 v[92:95], v186 offset:7168
    v_mfma_f32_16x16x32_bf16 v[28:31], v[112:115], v[156:159], v[28:31]
    ds_read2_b32 v[60:61], v179 offset0:80 offset1:81
    v_mfma_f32_16x16x32_bf16 v[32:35], v[124:127], v[148:151], v[32:35]
    ds_read2_b32 v[62:63], v179 offset0:82 offset1:83
    v_mfma_f32_16x16x32_bf16 v[32:35], v[116:119], v[156:159], v[32:35]
    ds_read_b128 v[96:99], v186 offset:9216
    v_mfma_f32_16x16x32_bf16 v[36:39], v[124:127], v[152:155], v[36:39]
    ds_read2_b32 v[64:65], v180 offset0:80 offset1:81
    v_mfma_f32_16x16x32_bf16 v[36:39], v[120:123], v[156:159], v[36:39]
    ds_read2_b32 v[66:67], v180 offset0:82 offset1:83
    v_mfma_f32_16x16x32_bf16 v[40:43], v[124:127], v[156:159], v[40:43]
    ds_read_b128 v[100:103], v186 offset:11264
    v_mfma_f32_16x16x32_bf16 v[32:35], v[128:131], v[144:147], v[32:35]
    ds_read2_b32 v[68:69], v181 offset0:80 offset1:81
    v_mfma_f32_16x16x32_bf16 v[32:35], v[112:115], v[160:163], v[32:35]
    ds_read2_b32 v[70:71], v181 offset0:82 offset1:83
    v_mfma_f32_16x16x32_bf16 v[36:39], v[128:131], v[148:151], v[36:39]
    ds_read_b128 v[104:107], v186 offset:13312
    v_mfma_f32_16x16x32_bf16 v[36:39], v[116:119], v[160:163], v[36:39]
    ds_read2_b32 v[72:73], v182 offset0:80 offset1:81
    v_mfma_f32_16x16x32_bf16 v[40:43], v[128:131], v[152:155], v[40:43]
    ds_read2_b32 v[74:75], v182 offset0:82 offset1:83
    v_mfma_f32_16x16x32_bf16 v[40:43], v[120:123], v[160:163], v[40:43]
    ds_read_b128 v[108:111], v186 offset:15360
    v_mfma_f32_16x16x32_bf16 v[44:47], v[128:131], v[156:159], v[44:47]
    ds_read2_b32 v[76:77], v183 offset0:80 offset1:81
    v_mfma_f32_16x16x32_bf16 v[44:47], v[124:127], v[160:163], v[44:47]
    ds_read2_b32 v[78:79], v183 offset0:82 offset1:83
    v_mfma_f32_16x16x32_bf16 v[36:39], v[132:135], v[144:147], v[36:39]
    v_mfma_f32_16x16x32_bf16 v[36:39], v[112:115], v[164:167], v[36:39]
    v_mfma_f32_16x16x32_bf16 v[40:43], v[132:135], v[148:151], v[40:43]
    v_mfma_f32_16x16x32_bf16 v[40:43], v[116:119], v[164:167], v[40:43]
    v_mfma_f32_16x16x32_bf16 v[44:47], v[132:135], v[152:155], v[44:47]
    v_mfma_f32_16x16x32_bf16 v[44:47], v[120:123], v[164:167], v[44:47]
    s_waitcnt lgkmcnt(15)
    v_mfma_f32_16x16x32_bf16 v[40:43], v[136:139], v[144:147], v[40:43]
    v_mfma_f32_16x16x32_bf16 v[40:43], v[112:115], v[168:171], v[40:43]
    v_mfma_f32_16x16x32_bf16 v[44:47], v[136:139], v[148:151], v[44:47]
    v_mfma_f32_16x16x32_bf16 v[44:47], v[116:119], v[168:171], v[44:47]
    v_mfma_f32_16x16x32_bf16 v[44:47], v[140:143], v[144:147], v[44:47]
    v_mfma_f32_16x16x32_bf16 v[44:47], v[112:115], v[172:175], v[44:47]
    v_mfma_f32_16x16x32_bf16 v[16:19], v[48:51], v[80:83], v[16:19]
    ds_read_b128 v[144:147], v187 offset:1024
    v_mfma_f32_16x16x32_bf16 v[20:23], v[52:55], v[80:83], v[20:23]
    ds_read2_b32 v[112:113], v176 offset0:64 offset1:65
    v_mfma_f32_16x16x32_bf16 v[20:23], v[48:51], v[84:87], v[20:23]
    ds_read2_b32 v[114:115], v176 offset0:66 offset1:67
    v_mfma_f32_16x16x32_bf16 v[24:27], v[52:55], v[84:87], v[24:27]
    ds_read_b128 v[148:151], v187 offset:3072
    v_mfma_f32_16x16x32_bf16 v[24:27], v[56:59], v[80:83], v[24:27]
    ds_read2_b32 v[116:117], v177 offset0:64 offset1:65
    v_mfma_f32_16x16x32_bf16 v[24:27], v[48:51], v[88:91], v[24:27]
    ds_read2_b32 v[118:119], v177 offset0:66 offset1:67
    v_mfma_f32_16x16x32_bf16 v[28:31], v[56:59], v[84:87], v[28:31]
    ds_read_b128 v[152:155], v187 offset:5120
    v_mfma_f32_16x16x32_bf16 v[28:31], v[52:55], v[88:91], v[28:31]
    ds_read2_b32 v[120:121], v178 offset0:64 offset1:65
    v_mfma_f32_16x16x32_bf16 v[32:35], v[56:59], v[88:91], v[32:35]
    ds_read2_b32 v[122:123], v178 offset0:66 offset1:67
    s_waitcnt lgkmcnt(15)
    v_mfma_f32_16x16x32_bf16 v[28:31], v[60:63], v[80:83], v[28:31]
    ds_read_b128 v[156:159], v187 offset:7168
    v_mfma_f32_16x16x32_bf16 v[28:31], v[48:51], v[92:95], v[28:31]
    ds_read2_b32 v[124:125], v179 offset0:64 offset1:65
    v_mfma_f32_16x16x32_bf16 v[32:35], v[60:63], v[84:87], v[32:35]
    ds_read2_b32 v[126:127], v179 offset0:66 offset1:67
    v_mfma_f32_16x16x32_bf16 v[32:35], v[52:55], v[92:95], v[32:35]
    ds_read_b128 v[160:163], v187 offset:9216
    v_mfma_f32_16x16x32_bf16 v[36:39], v[60:63], v[88:91], v[36:39]
    ds_read2_b32 v[128:129], v180 offset0:64 offset1:65
    v_mfma_f32_16x16x32_bf16 v[36:39], v[56:59], v[92:95], v[36:39]
    ds_read2_b32 v[130:131], v180 offset0:66 offset1:67
    v_mfma_f32_16x16x32_bf16 v[40:43], v[60:63], v[92:95], v[40:43]
    ds_read_b128 v[164:167], v187 offset:11264
    v_mfma_f32_16x16x32_bf16 v[32:35], v[64:67], v[80:83], v[32:35]
    ds_read2_b32 v[132:133], v181 offset0:64 offset1:65
    v_mfma_f32_16x16x32_bf16 v[32:35], v[48:51], v[96:99], v[32:35]
    ds_read2_b32 v[134:135], v181 offset0:66 offset1:67
    v_mfma_f32_16x16x32_bf16 v[36:39], v[64:67], v[84:87], v[36:39]
    ds_read_b128 v[168:171], v187 offset:13312
    v_mfma_f32_16x16x32_bf16 v[36:39], v[52:55], v[96:99], v[36:39]
    ds_read2_b32 v[136:137], v182 offset0:64 offset1:65
    v_mfma_f32_16x16x32_bf16 v[40:43], v[64:67], v[88:91], v[40:43]
    ds_read2_b32 v[138:139], v182 offset0:66 offset1:67
    v_mfma_f32_16x16x32_bf16 v[40:43], v[56:59], v[96:99], v[40:43]
    ds_read_b128 v[172:175], v187 offset:15360
    v_mfma_f32_16x16x32_bf16 v[44:47], v[64:67], v[92:95], v[44:47]
    ds_read2_b32 v[140:141], v183 offset0:64 offset1:65
    v_mfma_f32_16x16x32_bf16 v[44:47], v[60:63], v[96:99], v[44:47]
    ds_read2_b32 v[142:143], v183 offset0:66 offset1:67
    v_mfma_f32_16x16x32_bf16 v[36:39], v[68:71], v[80:83], v[36:39]
    ds_read_b64 v[192:193], v188 offset:0
    v_mfma_f32_16x16x32_bf16 v[36:39], v[48:51], v[100:103], v[36:39]
    ds_read_b64 v[224:225], v189 offset:0
    v_mfma_f32_16x16x32_bf16 v[40:43], v[68:71], v[84:87], v[40:43]
    ds_read_b64 v[196:197], v188 offset:2048
    v_mfma_f32_16x16x32_bf16 v[40:43], v[52:55], v[100:103], v[40:43]
    ds_read_b64 v[228:229], v189 offset:2048
    v_mfma_f32_16x16x32_bf16 v[44:47], v[68:71], v[88:91], v[44:47]
    ds_read_b64 v[200:201], v188 offset:4096
    v_mfma_f32_16x16x32_bf16 v[44:47], v[56:59], v[100:103], v[44:47]
    ds_read_b64 v[232:233], v189 offset:4096
    s_waitcnt lgkmcnt(15)
    v_mfma_f32_16x16x32_bf16 v[40:43], v[72:75], v[80:83], v[40:43]
    ds_read_b64 v[204:205], v188 offset:6144
    v_mfma_f32_16x16x32_bf16 v[40:43], v[48:51], v[104:107], v[40:43]
    ds_read_b64 v[236:237], v189 offset:6144
    v_mfma_f32_16x16x32_bf16 v[44:47], v[72:75], v[84:87], v[44:47]
    ds_read_b64 v[208:209], v188 offset:8192
    v_mfma_f32_16x16x32_bf16 v[44:47], v[52:55], v[104:107], v[44:47]
    ds_read_b64 v[240:241], v189 offset:8192
    v_mfma_f32_16x16x32_bf16 v[44:47], v[76:79], v[80:83], v[44:47]
    ds_read_b64 v[212:213], v188 offset:10240
    v_mfma_f32_16x16x32_bf16 v[44:47], v[48:51], v[108:111], v[44:47]
    ds_read_b64 v[244:245], v189 offset:10240
    v_mfma_f32_16x16x32_bf16 v[16:19], v[112:115], v[144:147], v[16:19]
    ds_read_b128 v[80:83], v184 offset:0
    v_mfma_f32_16x16x32_bf16 v[20:23], v[116:119], v[144:147], v[20:23]
    ds_read2_b32 v[48:49], v176 offset0:48 offset1:49
    v_mfma_f32_16x16x32_bf16 v[20:23], v[112:115], v[148:151], v[20:23]
    ds_read2_b32 v[50:51], v176 offset0:50 offset1:51
    v_mfma_f32_16x16x32_bf16 v[24:27], v[116:119], v[148:151], v[24:27]
    ds_read_b128 v[84:87], v184 offset:2048
    v_mfma_f32_16x16x32_bf16 v[24:27], v[120:123], v[144:147], v[24:27]
    ds_read2_b32 v[52:53], v177 offset0:48 offset1:49
    v_mfma_f32_16x16x32_bf16 v[24:27], v[112:115], v[152:155], v[24:27]
    ds_read2_b32 v[54:55], v177 offset0:50 offset1:51
    v_mfma_f32_16x16x32_bf16 v[28:31], v[120:123], v[148:151], v[28:31]
    ds_read_b128 v[88:91], v184 offset:4096
    v_mfma_f32_16x16x32_bf16 v[28:31], v[116:119], v[152:155], v[28:31]
    ds_read2_b32 v[56:57], v178 offset0:48 offset1:49
    v_mfma_f32_16x16x32_bf16 v[32:35], v[120:123], v[152:155], v[32:35]
    ds_read2_b32 v[58:59], v178 offset0:50 offset1:51
    v_mfma_f32_16x16x32_bf16 v[28:31], v[124:127], v[144:147], v[28:31]
    ds_read_b128 v[92:95], v184 offset:6144
    v_mfma_f32_16x16x32_bf16 v[28:31], v[112:115], v[156:159], v[28:31]
    ds_read2_b32 v[60:61], v179 offset0:48 offset1:49
    v_mfma_f32_16x16x32_bf16 v[32:35], v[124:127], v[148:151], v[32:35]
    ds_read2_b32 v[62:63], v179 offset0:50 offset1:51
    v_mfma_f32_16x16x32_bf16 v[32:35], v[116:119], v[156:159], v[32:35]
    ds_read_b128 v[96:99], v184 offset:8192
    v_mfma_f32_16x16x32_bf16 v[36:39], v[124:127], v[152:155], v[36:39]
    ds_read2_b32 v[64:65], v180 offset0:48 offset1:49
    v_mfma_f32_16x16x32_bf16 v[36:39], v[120:123], v[156:159], v[36:39]
    ds_read2_b32 v[66:67], v180 offset0:50 offset1:51
    v_mfma_f32_16x16x32_bf16 v[40:43], v[124:127], v[156:159], v[40:43]
    ds_read_b128 v[100:103], v184 offset:10240
    v_mfma_f32_16x16x32_bf16 v[32:35], v[128:131], v[144:147], v[32:35]
    ds_read2_b32 v[68:69], v181 offset0:48 offset1:49
    v_mfma_f32_16x16x32_bf16 v[32:35], v[112:115], v[160:163], v[32:35]
    ds_read2_b32 v[70:71], v181 offset0:50 offset1:51
    v_mfma_f32_16x16x32_bf16 v[36:39], v[128:131], v[148:151], v[36:39]
    ds_read_b128 v[104:107], v184 offset:12288
    v_mfma_f32_16x16x32_bf16 v[36:39], v[116:119], v[160:163], v[36:39]
    ds_read2_b32 v[72:73], v182 offset0:48 offset1:49
    v_mfma_f32_16x16x32_bf16 v[40:43], v[128:131], v[152:155], v[40:43]
    ds_read2_b32 v[74:75], v182 offset0:50 offset1:51
    v_mfma_f32_16x16x32_bf16 v[40:43], v[120:123], v[160:163], v[40:43]
    ds_read_b128 v[108:111], v184 offset:14336
    v_mfma_f32_16x16x32_bf16 v[44:47], v[128:131], v[156:159], v[44:47]
    ds_read2_b32 v[76:77], v183 offset0:48 offset1:49
    v_mfma_f32_16x16x32_bf16 v[44:47], v[124:127], v[160:163], v[44:47]
    ds_read2_b32 v[78:79], v183 offset0:50 offset1:51
    s_waitcnt lgkmcnt(15)
    v_mfma_f32_16x16x32_bf16 v[36:39], v[132:135], v[144:147], v[36:39]
    ds_read_b64 v[216:217], v188 offset:12288
    v_mfma_f32_16x16x32_bf16 v[36:39], v[112:115], v[164:167], v[36:39]
    ds_read_b64 v[248:249], v189 offset:12288
    v_mfma_f32_16x16x32_bf16 v[40:43], v[132:135], v[148:151], v[40:43]
    ds_read_b64 v[220:221], v188 offset:14336
    v_mfma_f32_16x16x32_bf16 v[40:43], v[116:119], v[164:167], v[40:43]
    ds_read_b64 v[252:253], v189 offset:14336
    v_mfma_f32_16x16x32_bf16 v[44:47], v[132:135], v[152:155], v[44:47]
    v_lshlrev_b32 v190, 16, v192
    v_and_b32 v191, 0xffff0000, v192
    v_mfma_f32_16x16x32_bf16 v[44:47], v[120:123], v[164:167], v[44:47]
    v_lshlrev_b32 v192, 16, v193
    v_and_b32 v193, 0xffff0000, v193
    v_mfma_f32_16x16x32_bf16 v[40:43], v[136:139], v[144:147], v[40:43]
    v_lshlrev_b32 v222, 16, v224
    v_and_b32 v223, 0xffff0000, v224
    v_mfma_f32_16x16x32_bf16 v[40:43], v[112:115], v[168:171], v[40:43]
    v_lshlrev_b32 v224, 16, v225
    v_and_b32 v225, 0xffff0000, v225
    v_mfma_f32_16x16x32_bf16 v[44:47], v[136:139], v[148:151], v[44:47]
    v_fmac_f32 v222, s34, v190
    v_fmac_f32 v223, s34, v191
    v_mfma_f32_16x16x32_bf16 v[44:47], v[116:119], v[168:171], v[44:47]
    v_fmac_f32 v224, s34, v192
    v_fmac_f32 v225, s34, v193
    v_mfma_f32_16x16x32_bf16 v[44:47], v[140:143], v[144:147], v[44:47]
    v_lshlrev_b32 v194, 16, v196
    v_and_b32 v195, 0xffff0000, v196
    v_mfma_f32_16x16x32_bf16 v[44:47], v[112:115], v[172:175], v[44:47]
    v_lshlrev_b32 v196, 16, v197
    v_and_b32 v197, 0xffff0000, v197
    v_mfma_f32_16x16x32_bf16 v[16:19], v[48:51], v[80:83], v[16:19]
    ds_read_b128 v[144:147], v185 offset:0
    v_mfma_f32_16x16x32_bf16 v[20:23], v[52:55], v[80:83], v[20:23]
    ds_read2_b32 v[112:113], v176 offset0:32 offset1:33
    v_mfma_f32_16x16x32_bf16 v[20:23], v[48:51], v[84:87], v[20:23]
    ds_read2_b32 v[114:115], v176 offset0:34 offset1:35
    v_mfma_f32_16x16x32_bf16 v[24:27], v[52:55], v[84:87], v[24:27]
    ds_read_b128 v[148:151], v185 offset:2048
    v_mfma_f32_16x16x32_bf16 v[24:27], v[56:59], v[80:83], v[24:27]
    ds_read2_b32 v[116:117], v177 offset0:32 offset1:33
    v_mfma_f32_16x16x32_bf16 v[24:27], v[48:51], v[88:91], v[24:27]
    ds_read2_b32 v[118:119], v177 offset0:34 offset1:35
    v_mfma_f32_16x16x32_bf16 v[28:31], v[56:59], v[84:87], v[28:31]
    ds_read_b128 v[152:155], v185 offset:4096
    v_mfma_f32_16x16x32_bf16 v[28:31], v[52:55], v[88:91], v[28:31]
    ds_read2_b32 v[120:121], v178 offset0:32 offset1:33
    v_mfma_f32_16x16x32_bf16 v[32:35], v[56:59], v[88:91], v[32:35]
    ds_read2_b32 v[122:123], v178 offset0:34 offset1:35
    s_waitcnt lgkmcnt(15)
    v_mfma_f32_16x16x32_bf16 v[28:31], v[60:63], v[80:83], v[28:31]
    ds_read_b128 v[156:159], v185 offset:6144
    v_mfma_f32_16x16x32_bf16 v[28:31], v[48:51], v[92:95], v[28:31]
    ds_read2_b32 v[124:125], v179 offset0:32 offset1:33
    v_mfma_f32_16x16x32_bf16 v[32:35], v[60:63], v[84:87], v[32:35]
    ds_read2_b32 v[126:127], v179 offset0:34 offset1:35
    v_mfma_f32_16x16x32_bf16 v[32:35], v[52:55], v[92:95], v[32:35]
    ds_read_b128 v[160:163], v185 offset:8192
    v_mfma_f32_16x16x32_bf16 v[36:39], v[60:63], v[88:91], v[36:39]
    ds_read2_b32 v[128:129], v180 offset0:32 offset1:33
    v_mfma_f32_16x16x32_bf16 v[36:39], v[56:59], v[92:95], v[36:39]
    ds_read2_b32 v[130:131], v180 offset0:34 offset1:35
    v_mfma_f32_16x16x32_bf16 v[40:43], v[60:63], v[92:95], v[40:43]
    ds_read_b128 v[164:167], v185 offset:10240
    v_mfma_f32_16x16x32_bf16 v[32:35], v[64:67], v[80:83], v[32:35]
    ds_read2_b32 v[132:133], v181 offset0:32 offset1:33
    v_mfma_f32_16x16x32_bf16 v[32:35], v[48:51], v[96:99], v[32:35]
    ds_read2_b32 v[134:135], v181 offset0:34 offset1:35
    v_mfma_f32_16x16x32_bf16 v[36:39], v[64:67], v[84:87], v[36:39]
    ds_read_b128 v[168:171], v185 offset:12288
    v_mfma_f32_16x16x32_bf16 v[36:39], v[52:55], v[96:99], v[36:39]
    ds_read2_b32 v[136:137], v182 offset0:32 offset1:33
    v_mfma_f32_16x16x32_bf16 v[40:43], v[64:67], v[88:91], v[40:43]
    ds_read2_b32 v[138:139], v182 offset0:34 offset1:35
    v_mfma_f32_16x16x32_bf16 v[40:43], v[56:59], v[96:99], v[40:43]
    ds_read_b128 v[172:175], v185 offset:14336
    v_mfma_f32_16x16x32_bf16 v[44:47], v[64:67], v[92:95], v[44:47]
    ds_read2_b32 v[140:141], v183 offset0:32 offset1:33
    v_mfma_f32_16x16x32_bf16 v[44:47], v[60:63], v[96:99], v[44:47]
    ds_read2_b32 v[142:143], v183 offset0:34 offset1:35
    v_mfma_f32_16x16x32_bf16 v[36:39], v[68:71], v[80:83], v[36:39]
    v_lshlrev_b32 v226, 16, v228
    v_and_b32 v227, 0xffff0000, v228
    v_mfma_f32_16x16x32_bf16 v[36:39], v[48:51], v[100:103], v[36:39]
    v_lshlrev_b32 v228, 16, v229
    v_and_b32 v229, 0xffff0000, v229
    v_mfma_f32_16x16x32_bf16 v[40:43], v[68:71], v[84:87], v[40:43]
    v_fmac_f32 v226, s34, v194
    v_fmac_f32 v227, s34, v195
    v_mfma_f32_16x16x32_bf16 v[40:43], v[52:55], v[100:103], v[40:43]
    v_fmac_f32 v228, s34, v196
    v_fmac_f32 v229, s34, v197
    v_mfma_f32_16x16x32_bf16 v[44:47], v[68:71], v[88:91], v[44:47]
    v_lshlrev_b32 v198, 16, v200
    v_and_b32 v199, 0xffff0000, v200
    v_mfma_f32_16x16x32_bf16 v[44:47], v[56:59], v[100:103], v[44:47]
    v_lshlrev_b32 v200, 16, v201
    v_and_b32 v201, 0xffff0000, v201
    v_mfma_f32_16x16x32_bf16 v[40:43], v[72:75], v[80:83], v[40:43]
    v_lshlrev_b32 v230, 16, v232
    v_and_b32 v231, 0xffff0000, v232
    v_mfma_f32_16x16x32_bf16 v[40:43], v[48:51], v[104:107], v[40:43]
    v_lshlrev_b32 v232, 16, v233
    v_and_b32 v233, 0xffff0000, v233
    v_mfma_f32_16x16x32_bf16 v[44:47], v[72:75], v[84:87], v[44:47]
    v_fmac_f32 v230, s34, v198
    v_fmac_f32 v231, s34, v199
    v_mfma_f32_16x16x32_bf16 v[44:47], v[52:55], v[104:107], v[44:47]
    v_fmac_f32 v232, s34, v200
    v_fmac_f32 v233, s34, v201
    s_waitcnt lgkmcnt(15)
    v_mfma_f32_16x16x32_bf16 v[44:47], v[76:79], v[80:83], v[44:47]
    v_lshlrev_b32 v202, 16, v204
    v_and_b32 v203, 0xffff0000, v204
    v_mfma_f32_16x16x32_bf16 v[44:47], v[48:51], v[108:111], v[44:47]
    v_lshlrev_b32 v204, 16, v205
    v_and_b32 v205, 0xffff0000, v205
    v_mfma_f32_16x16x32_bf16 v[16:19], v[112:115], v[144:147], v[16:19]
    ds_read_b128 v[80:83], v186 offset:0
    v_mfma_f32_16x16x32_bf16 v[20:23], v[116:119], v[144:147], v[20:23]
    ds_read2_b32 v[48:49], v176 offset0:16 offset1:17
    v_mfma_f32_16x16x32_bf16 v[20:23], v[112:115], v[148:151], v[20:23]
    ds_read2_b32 v[50:51], v176 offset0:18 offset1:19
    v_mfma_f32_16x16x32_bf16 v[24:27], v[116:119], v[148:151], v[24:27]
    ds_read_b128 v[84:87], v186 offset:2048
    v_mfma_f32_16x16x32_bf16 v[24:27], v[120:123], v[144:147], v[24:27]
    ds_read2_b32 v[52:53], v177 offset0:16 offset1:17
    v_mfma_f32_16x16x32_bf16 v[24:27], v[112:115], v[152:155], v[24:27]
    ds_read2_b32 v[54:55], v177 offset0:18 offset1:19
    v_mfma_f32_16x16x32_bf16 v[28:31], v[120:123], v[148:151], v[28:31]
    ds_read_b128 v[88:91], v186 offset:4096
    v_mfma_f32_16x16x32_bf16 v[28:31], v[116:119], v[152:155], v[28:31]
    ds_read2_b32 v[56:57], v178 offset0:16 offset1:17
    v_mfma_f32_16x16x32_bf16 v[32:35], v[120:123], v[152:155], v[32:35]
    ds_read2_b32 v[58:59], v178 offset0:18 offset1:19
    s_waitcnt lgkmcnt(15)
    v_mfma_f32_16x16x32_bf16 v[28:31], v[124:127], v[144:147], v[28:31]
    ds_read_b128 v[92:95], v186 offset:6144
    v_mfma_f32_16x16x32_bf16 v[28:31], v[112:115], v[156:159], v[28:31]
    ds_read2_b32 v[60:61], v179 offset0:16 offset1:17
    v_mfma_f32_16x16x32_bf16 v[32:35], v[124:127], v[148:151], v[32:35]
    ds_read2_b32 v[62:63], v179 offset0:18 offset1:19
    v_mfma_f32_16x16x32_bf16 v[32:35], v[116:119], v[156:159], v[32:35]
    ds_read_b128 v[96:99], v186 offset:8192
    v_mfma_f32_16x16x32_bf16 v[36:39], v[124:127], v[152:155], v[36:39]
    ds_read2_b32 v[64:65], v180 offset0:16 offset1:17
    v_mfma_f32_16x16x32_bf16 v[36:39], v[120:123], v[156:159], v[36:39]
    ds_read2_b32 v[66:67], v180 offset0:18 offset1:19
    v_mfma_f32_16x16x32_bf16 v[40:43], v[124:127], v[156:159], v[40:43]
    ds_read_b128 v[100:103], v186 offset:10240
    v_mfma_f32_16x16x32_bf16 v[32:35], v[128:131], v[144:147], v[32:35]
    ds_read2_b32 v[68:69], v181 offset0:16 offset1:17
    v_mfma_f32_16x16x32_bf16 v[32:35], v[112:115], v[160:163], v[32:35]
    ds_read2_b32 v[70:71], v181 offset0:18 offset1:19
    v_mfma_f32_16x16x32_bf16 v[36:39], v[128:131], v[148:151], v[36:39]
    ds_read_b128 v[104:107], v186 offset:12288
    v_mfma_f32_16x16x32_bf16 v[36:39], v[116:119], v[160:163], v[36:39]
    ds_read2_b32 v[72:73], v182 offset0:16 offset1:17
    v_mfma_f32_16x16x32_bf16 v[40:43], v[128:131], v[152:155], v[40:43]
    ds_read2_b32 v[74:75], v182 offset0:18 offset1:19
    v_mfma_f32_16x16x32_bf16 v[40:43], v[120:123], v[160:163], v[40:43]
    ds_read_b128 v[108:111], v186 offset:14336
    v_mfma_f32_16x16x32_bf16 v[44:47], v[128:131], v[156:159], v[44:47]
    ds_read2_b32 v[76:77], v183 offset0:16 offset1:17
    v_mfma_f32_16x16x32_bf16 v[44:47], v[124:127], v[160:163], v[44:47]
    ds_read2_b32 v[78:79], v183 offset0:18 offset1:19
    v_mfma_f32_16x16x32_bf16 v[36:39], v[132:135], v[144:147], v[36:39]
    v_lshlrev_b32 v234, 16, v236
    v_and_b32 v235, 0xffff0000, v236
    v_mfma_f32_16x16x32_bf16 v[36:39], v[112:115], v[164:167], v[36:39]
    v_lshlrev_b32 v236, 16, v237
    v_and_b32 v237, 0xffff0000, v237
    v_mfma_f32_16x16x32_bf16 v[40:43], v[132:135], v[148:151], v[40:43]
    v_fmac_f32 v234, s34, v202
    v_fmac_f32 v235, s34, v203
    v_mfma_f32_16x16x32_bf16 v[40:43], v[116:119], v[164:167], v[40:43]
    v_fmac_f32 v236, s34, v204
    v_fmac_f32 v237, s34, v205
    v_mfma_f32_16x16x32_bf16 v[44:47], v[132:135], v[152:155], v[44:47]
    v_lshlrev_b32 v206, 16, v208
    v_and_b32 v207, 0xffff0000, v208
    v_mfma_f32_16x16x32_bf16 v[44:47], v[120:123], v[164:167], v[44:47]
    v_lshlrev_b32 v208, 16, v209
    v_and_b32 v209, 0xffff0000, v209
    s_waitcnt lgkmcnt(15)
    v_mfma_f32_16x16x32_bf16 v[40:43], v[136:139], v[144:147], v[40:43]
    v_lshlrev_b32 v238, 16, v240
    v_and_b32 v239, 0xffff0000, v240
    v_mfma_f32_16x16x32_bf16 v[40:43], v[112:115], v[168:171], v[40:43]
    v_lshlrev_b32 v240, 16, v241
    v_and_b32 v241, 0xffff0000, v241
    v_mfma_f32_16x16x32_bf16 v[44:47], v[136:139], v[148:151], v[44:47]
    v_fmac_f32 v238, s34, v206
    v_fmac_f32 v239, s34, v207
    v_mfma_f32_16x16x32_bf16 v[44:47], v[116:119], v[168:171], v[44:47]
    v_fmac_f32 v240, s34, v208
    v_fmac_f32 v241, s34, v209
    v_mfma_f32_16x16x32_bf16 v[44:47], v[140:143], v[144:147], v[44:47]
    v_lshlrev_b32 v210, 16, v212
    v_and_b32 v211, 0xffff0000, v212
    v_mfma_f32_16x16x32_bf16 v[44:47], v[112:115], v[172:175], v[44:47]
    v_lshlrev_b32 v212, 16, v213
    v_and_b32 v213, 0xffff0000, v213
    v_mfma_f32_16x16x32_bf16 v[16:19], v[48:51], v[80:83], v[16:19]
    ds_read_b128 v[144:147], v187 offset:0
    v_mfma_f32_16x16x32_bf16 v[20:23], v[52:55], v[80:83], v[20:23]
    ds_read2_b32 v[112:113], v176 offset0:0 offset1:1
    v_mfma_f32_16x16x32_bf16 v[20:23], v[48:51], v[84:87], v[20:23]
    ds_read2_b32 v[114:115], v176 offset0:2 offset1:3
    v_mfma_f32_16x16x32_bf16 v[24:27], v[52:55], v[84:87], v[24:27]
    ds_read_b128 v[148:151], v187 offset:2048
    v_mfma_f32_16x16x32_bf16 v[24:27], v[56:59], v[80:83], v[24:27]
    ds_read2_b32 v[116:117], v177 offset0:0 offset1:1
    v_mfma_f32_16x16x32_bf16 v[24:27], v[48:51], v[88:91], v[24:27]
    ds_read2_b32 v[118:119], v177 offset0:2 offset1:3
    v_mfma_f32_16x16x32_bf16 v[28:31], v[56:59], v[84:87], v[28:31]
    ds_read_b128 v[152:155], v187 offset:4096
    v_mfma_f32_16x16x32_bf16 v[28:31], v[52:55], v[88:91], v[28:31]
    ds_read2_b32 v[120:121], v178 offset0:0 offset1:1
    v_mfma_f32_16x16x32_bf16 v[32:35], v[56:59], v[88:91], v[32:35]
    ds_read2_b32 v[122:123], v178 offset0:2 offset1:3
    s_waitcnt lgkmcnt(15)
    v_mfma_f32_16x16x32_bf16 v[28:31], v[60:63], v[80:83], v[28:31]
    ds_read_b128 v[156:159], v187 offset:6144
    v_mfma_f32_16x16x32_bf16 v[28:31], v[48:51], v[92:95], v[28:31]
    ds_read2_b32 v[124:125], v179 offset0:0 offset1:1
    v_mfma_f32_16x16x32_bf16 v[32:35], v[60:63], v[84:87], v[32:35]
    ds_read2_b32 v[126:127], v179 offset0:2 offset1:3
    v_mfma_f32_16x16x32_bf16 v[32:35], v[52:55], v[92:95], v[32:35]
    ds_read_b128 v[160:163], v187 offset:8192
    v_mfma_f32_16x16x32_bf16 v[36:39], v[60:63], v[88:91], v[36:39]
    ds_read2_b32 v[128:129], v180 offset0:0 offset1:1
    v_mfma_f32_16x16x32_bf16 v[36:39], v[56:59], v[92:95], v[36:39]
    ds_read2_b32 v[130:131], v180 offset0:2 offset1:3
    v_mfma_f32_16x16x32_bf16 v[40:43], v[60:63], v[92:95], v[40:43]
    ds_read_b128 v[164:167], v187 offset:10240
    v_mfma_f32_16x16x32_bf16 v[32:35], v[64:67], v[80:83], v[32:35]
    ds_read2_b32 v[132:133], v181 offset0:0 offset1:1
    v_mfma_f32_16x16x32_bf16 v[32:35], v[48:51], v[96:99], v[32:35]
    ds_read2_b32 v[134:135], v181 offset0:2 offset1:3
    v_mfma_f32_16x16x32_bf16 v[36:39], v[64:67], v[84:87], v[36:39]
    ds_read_b128 v[168:171], v187 offset:12288
    v_mfma_f32_16x16x32_bf16 v[36:39], v[52:55], v[96:99], v[36:39]
    ds_read2_b32 v[136:137], v182 offset0:0 offset1:1
    v_mfma_f32_16x16x32_bf16 v[40:43], v[64:67], v[88:91], v[40:43]
    ds_read2_b32 v[138:139], v182 offset0:2 offset1:3
    v_mfma_f32_16x16x32_bf16 v[40:43], v[56:59], v[96:99], v[40:43]
    ds_read_b128 v[172:175], v187 offset:14336
    v_mfma_f32_16x16x32_bf16 v[44:47], v[64:67], v[92:95], v[44:47]
    ds_read2_b32 v[140:141], v183 offset0:0 offset1:1
    v_mfma_f32_16x16x32_bf16 v[44:47], v[60:63], v[96:99], v[44:47]
    ds_read2_b32 v[142:143], v183 offset0:2 offset1:3
    v_mfma_f32_16x16x32_bf16 v[36:39], v[68:71], v[80:83], v[36:39]
    v_lshlrev_b32 v242, 16, v244
    v_and_b32 v243, 0xffff0000, v244
    v_mfma_f32_16x16x32_bf16 v[36:39], v[48:51], v[100:103], v[36:39]
    v_lshlrev_b32 v244, 16, v245
    v_and_b32 v245, 0xffff0000, v245
    v_mfma_f32_16x16x32_bf16 v[40:43], v[68:71], v[84:87], v[40:43]
    v_fmac_f32 v242, s34, v210
    v_fmac_f32 v243, s34, v211
    v_mfma_f32_16x16x32_bf16 v[40:43], v[52:55], v[100:103], v[40:43]
    v_fmac_f32 v244, s34, v212
    v_fmac_f32 v245, s34, v213
    v_mfma_f32_16x16x32_bf16 v[44:47], v[68:71], v[88:91], v[44:47]
    v_lshlrev_b32 v214, 16, v216
    v_and_b32 v215, 0xffff0000, v216
    v_mfma_f32_16x16x32_bf16 v[44:47], v[56:59], v[100:103], v[44:47]
    v_lshlrev_b32 v216, 16, v217
    v_and_b32 v217, 0xffff0000, v217
    s_waitcnt lgkmcnt(15)
    v_mfma_f32_16x16x32_bf16 v[40:43], v[72:75], v[80:83], v[40:43]
    v_lshlrev_b32 v246, 16, v248
    v_and_b32 v247, 0xffff0000, v248
    v_mfma_f32_16x16x32_bf16 v[40:43], v[48:51], v[104:107], v[40:43]
    v_lshlrev_b32 v248, 16, v249
    v_and_b32 v249, 0xffff0000, v249
    v_mfma_f32_16x16x32_bf16 v[44:47], v[72:75], v[84:87], v[44:47]
    v_fmac_f32 v246, s34, v214
    v_fmac_f32 v247, s34, v215
    v_mfma_f32_16x16x32_bf16 v[44:47], v[52:55], v[104:107], v[44:47]
    v_fmac_f32 v248, s34, v216
    v_fmac_f32 v249, s34, v217
    v_mfma_f32_16x16x32_bf16 v[44:47], v[76:79], v[80:83], v[44:47]
    v_lshlrev_b32 v218, 16, v220
    v_and_b32 v219, 0xffff0000, v220
    v_mfma_f32_16x16x32_bf16 v[44:47], v[48:51], v[108:111], v[44:47]
    v_lshlrev_b32 v220, 16, v221
    v_and_b32 v221, 0xffff0000, v221
    v_mfma_f32_16x16x32_bf16 v[16:19], v[112:115], v[144:147], v[16:19]
    v_lshlrev_b32 v250, 16, v252
    v_and_b32 v251, 0xffff0000, v252
    v_mfma_f32_16x16x32_bf16 v[20:23], v[116:119], v[144:147], v[20:23]
    v_lshlrev_b32 v252, 16, v253
    v_and_b32 v253, 0xffff0000, v253
    v_mfma_f32_16x16x32_bf16 v[20:23], v[112:115], v[148:151], v[20:23]
    v_fmac_f32 v250, s34, v218
    v_fmac_f32 v251, s34, v219
    v_mfma_f32_16x16x32_bf16 v[24:27], v[116:119], v[148:151], v[24:27]
    v_fmac_f32 v252, s34, v220
    v_fmac_f32 v253, s34, v221
    v_mfma_f32_16x16x32_bf16 v[24:27], v[120:123], v[144:147], v[24:27]
    v_add_f32 v16, v16, v222
    v_add_f32 v17, v17, v223
    v_mfma_f32_16x16x32_bf16 v[24:27], v[112:115], v[152:155], v[24:27]
    v_add_f32 v18, v18, v224
    v_add_f32 v19, v19, v225
    v_mfma_f32_16x16x32_bf16 v[28:31], v[120:123], v[148:151], v[28:31]
    v_cvt_pk_bf16_f32 v48, v16, v17
    v_cvt_pk_bf16_f32 v49, v18, v19
    v_mfma_f32_16x16x32_bf16 v[28:31], v[116:119], v[152:155], v[28:31]
    v_add_f32 v20, v20, v226
    v_add_f32 v21, v21, v227
    v_mfma_f32_16x16x32_bf16 v[32:35], v[120:123], v[152:155], v[32:35]
    v_add_f32 v22, v22, v228
    v_add_f32 v23, v23, v229
    s_waitcnt lgkmcnt(12)
    v_mfma_f32_16x16x32_bf16 v[28:31], v[124:127], v[144:147], v[28:31]
    v_cvt_pk_bf16_f32 v50, v20, v21
    v_cvt_pk_bf16_f32 v51, v22, v23
    v_mfma_f32_16x16x32_bf16 v[28:31], v[112:115], v[156:159], v[28:31]
    v_permlane16_swap_b32 v48, v50
    v_permlane16_swap_b32 v49, v51
    v_mfma_f32_16x16x32_bf16 v[32:35], v[124:127], v[148:151], v[32:35]
    buffer_store_dwordx4 v[48:51], v5, s[8:11], s35 offen offset:0 sc1
    v_add_f32 v24, v24, v230
    v_mfma_f32_16x16x32_bf16 v[32:35], v[116:119], v[156:159], v[32:35]
    v_add_f32 v25, v25, v231
    v_add_f32 v26, v26, v232
    v_mfma_f32_16x16x32_bf16 v[36:39], v[124:127], v[152:155], v[36:39]
    v_add_f32 v27, v27, v233
    v_cvt_pk_bf16_f32 v52, v24, v25
    v_mfma_f32_16x16x32_bf16 v[36:39], v[120:123], v[156:159], v[36:39]
    v_cvt_pk_bf16_f32 v53, v26, v27
    v_add_f32 v28, v28, v234
    v_mfma_f32_16x16x32_bf16 v[40:43], v[124:127], v[156:159], v[40:43]
    v_add_f32 v29, v29, v235
    v_add_f32 v30, v30, v236
    s_waitcnt lgkmcnt(9)
    v_mfma_f32_16x16x32_bf16 v[32:35], v[128:131], v[144:147], v[32:35]
    v_add_f32 v31, v31, v237
    v_cvt_pk_bf16_f32 v54, v28, v29
    v_mfma_f32_16x16x32_bf16 v[32:35], v[112:115], v[160:163], v[32:35]
    v_cvt_pk_bf16_f32 v55, v30, v31
    v_permlane16_swap_b32 v52, v54
    v_mfma_f32_16x16x32_bf16 v[36:39], v[128:131], v[148:151], v[36:39]
    v_permlane16_swap_b32 v53, v55
    buffer_store_dwordx4 v[52:55], v5, s[8:11], s35 offen offset:1024 sc1
    v_mfma_f32_16x16x32_bf16 v[36:39], v[116:119], v[160:163], v[36:39]
    v_mfma_f32_16x16x32_bf16 v[40:43], v[128:131], v[152:155], v[40:43]
    v_mfma_f32_16x16x32_bf16 v[40:43], v[120:123], v[160:163], v[40:43]
    v_add_f32 v32, v32, v238
    v_add_f32 v33, v33, v239
    v_mfma_f32_16x16x32_bf16 v[44:47], v[128:131], v[156:159], v[44:47]
    v_add_f32 v34, v34, v240
    v_add_f32 v35, v35, v241
    v_mfma_f32_16x16x32_bf16 v[44:47], v[124:127], v[160:163], v[44:47]
    v_cvt_pk_bf16_f32 v56, v32, v33
    v_cvt_pk_bf16_f32 v57, v34, v35
    s_waitcnt lgkmcnt(6)
    v_mfma_f32_16x16x32_bf16 v[36:39], v[132:135], v[144:147], v[36:39]
    v_mfma_f32_16x16x32_bf16 v[36:39], v[112:115], v[164:167], v[36:39]
    v_mfma_f32_16x16x32_bf16 v[40:43], v[132:135], v[148:151], v[40:43]
    v_mfma_f32_16x16x32_bf16 v[40:43], v[116:119], v[164:167], v[40:43]
    v_mfma_f32_16x16x32_bf16 v[44:47], v[132:135], v[152:155], v[44:47]
    v_mfma_f32_16x16x32_bf16 v[44:47], v[120:123], v[164:167], v[44:47]
    s_nop 3
    v_add_f32 v36, v36, v242
    v_add_f32 v37, v37, v243
    s_waitcnt lgkmcnt(3)
    v_mfma_f32_16x16x32_bf16 v[40:43], v[136:139], v[144:147], v[40:43]
    v_add_f32 v38, v38, v244
    v_add_f32 v39, v39, v245
    v_mfma_f32_16x16x32_bf16 v[40:43], v[112:115], v[168:171], v[40:43]
    v_cvt_pk_bf16_f32 v58, v36, v37
    v_cvt_pk_bf16_f32 v59, v38, v39
    v_mfma_f32_16x16x32_bf16 v[44:47], v[136:139], v[148:151], v[44:47]
    v_permlane16_swap_b32 v56, v58
    v_permlane16_swap_b32 v57, v59
    v_mfma_f32_16x16x32_bf16 v[44:47], v[116:119], v[168:171], v[44:47]
    buffer_store_dwordx4 v[56:59], v5, s[8:11], s35 offen offset:2048 sc1
    s_waitcnt lgkmcnt(0)
    v_mfma_f32_16x16x32_bf16 v[44:47], v[140:143], v[144:147], v[44:47]
    v_mfma_f32_16x16x32_bf16 v[44:47], v[112:115], v[172:175], v[44:47]
    v_add_f32 v40, v40, v246
    v_add_f32 v41, v41, v247
    v_add_f32 v42, v42, v248
    v_add_f32 v43, v43, v249
    v_cvt_pk_bf16_f32 v60, v40, v41
    v_cvt_pk_bf16_f32 v61, v42, v43
    s_nop 1
    v_add_f32 v44, v44, v250
    v_add_f32 v45, v45, v251
    v_add_f32 v46, v46, v252
    v_add_f32 v47, v47, v253
    v_cvt_pk_bf16_f32 v62, v44, v45
    v_cvt_pk_bf16_f32 v63, v46, v47
    s_nop 0
    v_permlane16_swap_b32 v60, v62
    v_permlane16_swap_b32 v61, v63
    buffer_store_dwordx4 v[60:63], v5, s[8:11], s35 offen offset:3072 sc1
    s_waitcnt vmcnt(0)
    v_mov_b32 v2, 158760
    v_mov_b32 v3, 1
    s_mov_b64 exec, 1
    ds_add_rtn_u32 v3, v2, v3
    s_mov_b64 exec, -1
    s_waitcnt lgkmcnt(0)
    v_readfirstlane_b32 s57, v3
    s_nop 0
    s_cmp_lg_u32 s57, 3
    s_cbranch_scc1 L_notlast_14
    v_mov_b32 v2, 0
    v_mov_b32 v3, s18
    s_mov_b64 exec, 1
    buffer_store_dword v3, v2, s[8:11], s36 offen sc1
    s_mov_b64 exec, -1
L_notlast_14:
    s_branch L_cdone_5
L_noconv_4:
    s_mov_b32 s53, s19
    s_load_dword s18, s[4:5], 0
    s_barrier
    s_mov_b32 s8, s4
    s_and_b32 s9, s5, 0xffff
    s_mov_b32 s10, 268435456
    s_mov_b32 s11, 0x20000
    s_waitcnt lgkmcnt(0)
    s_add_u32 s18, s18, 1
    s_lshl_b32 s26, s53, 1
    s_lshl_b32 s36, s26, 6
    s_add_u32 s36, s36, 81920
    s_mul_i32 s29, s26, 2731
    s_lshr_b32 s29, s29, 16
    s_mul_i32 s30, s29, 24
    s_sub_u32 s30, s26, s30
    v_lshrrev_b32 v72, 3, v1
    v_mul_u32_u24 v72, 3072, v72
    v_and_b32 v73, 7, v1
    v_lshl_add_u32 v72, v73, 4, v72
    s_lshr_b32 s31, s29, 1
    s_lshl_b32 s31, s31, 2
    s_add_u32 s31, s31, s23
    s_mul_i32 s31, s31, 122880
    s_lshl_b32 s32, s30, 7
    s_add_u32 s31, s31, s32
    s_mul_i32 s32, s23, 5120
    s_bitcmp1_b32 s29, 0
    s_cselect_b32 s44, s46, s44
    s_cselect_b32 s45, s47, s45
    s_mov_b32 s12, s44
    s_and_b32 s13, s45, 0xffff
    s_mov_b32 s14, 1966080
    s_mov_b32 s15, 0x20000
    v_mov_b32 v14, 158728
    s_mov_b32 s59, 2097152
L_lw_16:
    ds_read_b32 v15, v14
    s_waitcnt lgkmcnt(0)
    v_readfirstlane_b32 s58, v15
    s_nop 0
    s_cmp_ge_u32 s58, 4
    s_cbranch_scc1 L_lwok_17
    s_sleep 1
    s_sub_u32 s59, s59, 1
    s_cmp_lg_u32 s59, 0
    s_cbranch_scc1 L_lw_16
L_lwok_17:
    s_add_u32 m0, s32, 41984
    s_add_u32 s33, s31, 0
    buffer_load_dwordx4 v72, s[12:15], s33 offen nt lds
    s_add_u32 m0, m0, 1024
    s_add_u32 s33, s33, 24576
    buffer_load_dwordx4 v72, s[12:15], s33 offen nt lds
    s_add_u32 m0, m0, 1024
    s_add_u32 s33, s33, 24576
    buffer_load_dwordx4 v72, s[12:15], s33 offen nt lds
    s_add_u32 m0, m0, 1024
    s_add_u32 s33, s33, 24576
    buffer_load_dwordx4 v72, s[12:15], s33 offen nt lds
    s_add_u32 m0, m0, 1024
    s_add_u32 s33, s33, 24576
    buffer_load_dwordx4 v72, s[12:15], s33 offen nt lds
    s_add_u32 m0, s32, 62464
    s_add_u32 s33, s31, 128
    buffer_load_dwordx4 v72, s[12:15], s33 offen nt lds
    s_add_u32 m0, m0, 1024
    s_add_u32 s33, s33, 24576
    buffer_load_dwordx4 v72, s[12:15], s33 offen nt lds
    s_add_u32 m0, m0, 1024
    s_add_u32 s33, s33, 24576
    buffer_load_dwordx4 v72, s[12:15], s33 offen nt lds
    s_add_u32 m0, m0, 1024
    s_add_u32 s33, s33, 24576
    buffer_load_dwordx4 v72, s[12:15], s33 offen nt lds
    s_add_u32 m0, m0, 1024
    s_add_u32 s33, s33, 24576
    buffer_load_dwordx4 v72, s[12:15], s33 offen nt lds
    s_cmp_lt_u32 s53, 88
    s_cbranch_scc1 L_nopf_18
    s_and_b32 s16, s16, 0xffffff00
    s_add_u32 s12, s16, sequential_preLN__ssm_conv_s4d__swiglu_ffn__prompt_kernel-sequential_preLN__ssm_conv_s4d__swiglu_ffn__prompt_kernel
    s_addc_u32 s13, s17, 0
    s_and_b32 s13, s13, 0xffff
    s_mov_b32 s14, code_end-sequential_preLN__ssm_conv_s4d__swiglu_ffn__prompt_kernel
    s_mov_b32 s15, 0x20000
    v_lshlrev_b32 v2, 7, v0
    buffer_load_dword v74, v2, s[12:15], 0 offen
    v_add_u32 v2, 32768, v2
    buffer_load_dword v75, v2, s[12:15], 0 offen
L_nopf_18:
    v_lshrrev_b32 v3, 4, v1
    v_lshlrev_b32 v4, 10, v3
    v_bfe_u32 v3, v1, 2, 2
    v_lshl_add_u32 v4, v3, 7, v4
    v_and_b32 v6, 3, v1
    v_lshl_add_u32 v4, v6, 3, v4
    s_lshl_b32 s31, s23, 5
    s_add_u32 s31, s31, 41984
    v_add_u32 v4, s31, v4
    v_lshlrev_b32 v5, 4, v1
    v_and_b32 v6, 15, v1
    v_lshlrev_b32 v6, 2, v6
    s_add_u32 s27, s30, 0
    s_lshl_b32 s27, s27, 2
    s_add_u32 s27, s27, s23
    s_mul_i32 s31, s27, 43
    s_lshr_b32 s31, s31, 8
    s_mul_i32 s32, s31, 6
    s_sub_u32 s32, s27, s32
    s_mul_i32 s31, s31, 20
    s_lshr_b32 s33, s29, 1
    s_mul_i32 s33, s33, 5
    s_add_u32 s31, s31, s33
    s_mul_i32 s31, s31, 12
    s_add_u32 s31, s31, s32
    s_cmp_ge_u32 s32, 3
    s_cselect_b32 s33, 3, 0
    s_add_u32 s31, s31, s33
    s_and_b32 s33, s29, 1
    s_mul_i32 s33, s33, 3
    s_add_u32 s31, s31, s33
    s_lshl_b32 s31, s31, 10
    s_add_u32 s38, s31, 8912896
    s_mul_i32 s33, s29, 6144
    s_lshl_b32 s32, s27, 6
    s_add_u32 s33, s33, s32
    s_add_u32 s39, s33, 524288
    s_add_u32 s27, s30, 1
    s_lshl_b32 s27, s27, 2
    s_add_u32 s27, s27, s23
    s_mul_i32 s31, s27, 43
    s_lshr_b32 s31, s31, 8
    s_mul_i32 s32, s31, 6
    s_sub_u32 s32, s27, s32
    s_mul_i32 s31, s31, 20
    s_lshr_b32 s33, s29, 1
    s_mul_i32 s33, s33, 5
    s_add_u32 s31, s31, s33
    s_mul_i32 s31, s31, 12
    s_add_u32 s31, s31, s32
    s_cmp_ge_u32 s32, 3
    s_cselect_b32 s33, 3, 0
    s_add_u32 s31, s31, s33
    s_and_b32 s33, s29, 1
    s_mul_i32 s33, s33, 3
    s_add_u32 s31, s31, s33
    s_lshl_b32 s31, s31, 10
    s_add_u32 s40, s31, 8912896
    s_mul_i32 s33, s29, 6144
    s_lshl_b32 s32, s27, 6
    s_add_u32 s33, s33, s32
    s_add_u32 s41, s33, 524288
    s_waitcnt vmcnt(0)
    v_mov_b32 v14, 158736
    v_mov_b32 v15, 1
    s_mov_b64 exec, 1
    ds_add_u32 v14, v15
    s_mov_b64 exec, -1
    v_mov_b32 v14, 158736
    s_mov_b32 s59, 2097152
L_lw_19:
    ds_read_b32 v15, v14
    s_waitcnt lgkmcnt(0)
    v_readfirstlane_b32 s58, v15
    s_nop 0
    s_cmp_ge_u32 s58, 4
    s_cbranch_scc1 L_lwok_20
    s_sleep 1
    s_sub_u32 s59, s59, 1
    s_cmp_lg_u32 s59, 0
    s_cbranch_scc1 L_lw_19
L_lwok_20:
    ds_read_b64_tr_b16 v[16:17], v4 offset:0
    ds_read_b64_tr_b16 v[18:19], v4 offset:512
    ds_read_b64_tr_b16 v[20:21], v4 offset:4096
    ds_read_b64_tr_b16 v[22:23], v4 offset:4608
    ds_read_b64_tr_b16 v[24:25], v4 offset:8192
    ds_read_b64_tr_b16 v[26:27], v4 offset:8704
    ds_read_b64_tr_b16 v[28:29], v4 offset:12288
    ds_read_b64_tr_b16 v[30:31], v4 offset:12800
    ds_read_b64_tr_b16 v[32:33], v4 offset:16384
    ds_read_b64_tr_b16 v[34:35], v4 offset:16896
    s_waitcnt lgkmcnt(8)
    buffer_store_dwordx4 v[16:19], v5, s[8:11], s38 offen sc1
    s_add_u32 s38, s38, 12288
    s_waitcnt lgkmcnt(6)
    buffer_store_dwordx4 v[20:23], v5, s[8:11], s38 offen sc1
    s_add_u32 s38, s38, 12288
    s_waitcnt lgkmcnt(4)
    buffer_store_dwordx4 v[24:27], v5, s[8:11], s38 offen sc1
    s_add_u32 s38, s38, 12288
    s_waitcnt lgkmcnt(2)
    buffer_store_dwordx4 v[28:31], v5, s[8:11], s38 offen sc1
    s_add_u32 s38, s38, 12288
    s_waitcnt lgkmcnt(0)
    buffer_store_dwordx4 v[32:35], v5, s[8:11], s38 offen sc1
    ds_read_b64_tr_b16 v[36:37], v4 offset:20480
    ds_read_b64_tr_b16 v[38:39], v4 offset:20992
    ds_read_b64_tr_b16 v[40:41], v4 offset:24576
    ds_read_b64_tr_b16 v[42:43], v4 offset:25088
    ds_read_b64_tr_b16 v[44:45], v4 offset:28672
    ds_read_b64_tr_b16 v[46:47], v4 offset:29184
    ds_read_b64_tr_b16 v[48:49], v4 offset:32768
    ds_read_b64_tr_b16 v[50:51], v4 offset:33280
    ds_read_b64_tr_b16 v[52:53], v4 offset:36864
    ds_read_b64_tr_b16 v[54:55], v4 offset:37376
    s_waitcnt lgkmcnt(8)
    buffer_store_dwordx4 v[36:39], v5, s[8:11], s40 offen sc1
    s_add_u32 s40, s40, 12288
    s_waitcnt lgkmcnt(6)
    buffer_store_dwordx4 v[40:43], v5, s[8:11], s40 offen sc1
    s_add_u32 s40, s40, 12288
    s_waitcnt lgkmcnt(4)
    buffer_store_dwordx4 v[44:47], v5, s[8:11], s40 offen sc1
    s_add_u32 s40, s40, 12288
    s_waitcnt lgkmcnt(2)
    buffer_store_dwordx4 v[48:51], v5, s[8:11], s40 offen sc1
    s_add_u32 s40, s40, 12288
    s_waitcnt lgkmcnt(0)
    buffer_store_dwordx4 v[52:55], v5, s[8:11], s40 offen sc1
    v_mov_b32 v8, 0
    v_mov_b32 v9, 0
    s_mov_b32 s34, 0x3f803f80
    v_dot2c_f32_bf16 v8, s34, v16
    v_dot2c_f32_bf16 v9, s34, v17
    v_dot2c_f32_bf16 v8, s34, v18
    v_dot2c_f32_bf16 v9, s34, v19
    v_dot2c_f32_bf16 v8, s34, v20
    v_dot2c_f32_bf16 v9, s34, v21
    v_dot2c_f32_bf16 v8, s34, v22
    v_dot2c_f32_bf16 v9, s34, v23
    v_dot2c_f32_bf16 v8, s34, v24
    v_dot2c_f32_bf16 v9, s34, v25
    v_dot2c_f32_bf16 v8, s34, v26
    v_dot2c_f32_bf16 v9, s34, v27
    v_dot2c_f32_bf16 v8, s34, v28
    v_dot2c_f32_bf16 v9, s34, v29
    v_dot2c_f32_bf16 v8, s34, v30
    v_dot2c_f32_bf16 v9, s34, v31
    v_dot2c_f32_bf16 v8, s34, v32
    v_dot2c_f32_bf16 v9, s34, v33
    v_dot2c_f32_bf16 v8, s34, v34
    v_dot2c_f32_bf16 v9, s34, v35
    s_nop 2
    v_add_f32 v8, v8, v9
    v_mov_b32 v9, v8
    s_nop 1
    v_permlane32_swap_b32 v8, v9
    v_add_f32 v8, v8, v9
    v_mov_b32 v9, v8
    s_nop 1
    v_permlane16_swap_b32 v8, v9
    v_add_f32 v10, v8, v9
    s_mov_b32 exec_lo, 0xffff
    s_mov_b32 exec_hi, 0
    buffer_store_dword v10, v6, s[8:11], s39 offen sc1
    s_mov_b64 exec, -1
    v_mov_b32 v8, 0
    v_mov_b32 v9, 0
    s_mov_b32 s34, 0x3f803f80
    v_dot2c_f32_bf16 v8, s34, v36
    v_dot2c_f32_bf16 v9, s34, v37
    v_dot2c_f32_bf16 v8, s34, v38
    v_dot2c_f32_bf16 v9, s34, v39
    v_dot2c_f32_bf16 v8, s34, v40
    v_dot2c_f32_bf16 v9, s34, v41
    v_dot2c_f32_bf16 v8, s34, v42
    v_dot2c_f32_bf16 v9, s34, v43
    v_dot2c_f32_bf16 v8, s34, v44
    v_dot2c_f32_bf16 v9, s34, v45
    v_dot2c_f32_bf16 v8, s34, v46
    v_dot2c_f32_bf16 v9, s34, v47
    v_dot2c_f32_bf16 v8, s34, v48
    v_dot2c_f32_bf16 v9, s34, v49
    v_dot2c_f32_bf16 v8, s34, v50
    v_dot2c_f32_bf16 v9, s34, v51
    v_dot2c_f32_bf16 v8, s34, v52
    v_dot2c_f32_bf16 v9, s34, v53
    v_dot2c_f32_bf16 v8, s34, v54
    v_dot2c_f32_bf16 v9, s34, v55
    s_nop 2
    v_add_f32 v8, v8, v9
    v_mov_b32 v9, v8
    s_nop 1
    v_permlane32_swap_b32 v8, v9
    v_add_f32 v8, v8, v9
    v_mov_b32 v9, v8
    s_nop 1
    v_permlane16_swap_b32 v8, v9
    v_add_f32 v10, v8, v9
    s_mov_b32 exec_lo, 0xffff
    s_mov_b32 exec_hi, 0
    buffer_store_dword v10, v6, s[8:11], s41 offen sc1
    s_mov_b64 exec, -1
    s_waitcnt vmcnt(0)
    v_mov_b32 v14, 158740
    v_mov_b32 v15, 1
    s_mov_b64 exec, 1
    ds_add_rtn_u32 v15, v14, v15
    s_mov_b64 exec, -1
    s_waitcnt lgkmcnt(0)
    v_readfirstlane_b32 s57, v15
    s_nop 0
    s_cmp_lg_u32 s57, 3
    s_cbranch_scc1 L_notlast_21
    v_lshlrev_b32 v14, 6, v1
    v_mov_b32 v15, s18
    s_mov_b64 exec, 3
    buffer_store_dword v15, v14, s[8:11], s36 offen sc1
    s_mov_b64 exec, -1
L_notlast_21:
    v_mov_b32 v14, 158764
    v_mov_b32 v15, 1
    s_mov_b64 exec, 1
    ds_add_u32 v14, v15
    s_mov_b64 exec, -1
    s_cmp_ge_u32 s53, 80
    s_cbranch_scc1 L_nof2_15
    s_mov_b32 s26, s53
    s_lshl_b32 s36, s26, 6
    s_add_u32 s36, s36, 65536
    s_mul_i32 s37, s26, 6554
    s_lshr_b32 s37, s37, 16
    s_mul_i32 s38, s37, 10
    s_sub_u32 s38, s26, s38
    v_lshrrev_b32 v12, 3, v1
    v_mul_u32_u24 v12, 1280, v12
    v_and_b32 v3, 7, v1
    v_lshl_add_u32 v12, v3, 4, v12
    s_mul_i32 s31, s20, 61440
    s_mul_i32 s32, s37, 245760
    s_add_u32 s31, s31, s32
    s_lshl_b32 s32, s38, 7
    s_add_u32 s31, s31, s32
    s_mul_i32 s32, s20, 6144
    s_add_u32 m0, s32, 86016
    s_mov_b32 s12, s48
    s_and_b32 s13, s49, 0xffff
    s_mov_b32 s14, 1966080
    s_mov_b32 s15, 0x20000
    buffer_load_dwordx4 v12, s[12:15], s31 offen nt lds
    s_add_u32 m0, m0, 1024
    s_add_u32 s31, s31, 10240
    buffer_load_dwordx4 v12, s[12:15], s31 offen nt lds
    s_add_u32 m0, m0, 1024
    s_add_u32 s31, s31, 10240
    buffer_load_dwordx4 v12, s[12:15], s31 offen nt lds
    s_add_u32 m0, m0, 1024
    s_add_u32 s31, s31, 10240
    buffer_load_dwordx4 v12, s[12:15], s31 offen nt lds
    s_add_u32 m0, m0, 1024
    s_add_u32 s31, s31, 10240
    buffer_load_dwordx4 v12, s[12:15], s31 offen nt lds
    s_add_u32 m0, m0, 1024
    s_add_u32 s31, s31, 10240
    buffer_load_dwordx4 v12, s[12:15], s31 offen nt lds
    v_lshrrev_b32 v7, 4, v1
    v_lshlrev_b32 v13, 10, v7
    v_bfe_u32 v3, v1, 2, 2
    v_lshl_add_u32 v13, v3, 7, v13
    v_and_b32 v6, 3, v1
    v_lshl_add_u32 v13, v6, 3, v13
    s_lshl_b32 s31, s20, 5
    s_add_u32 s31, s31, 86016
    v_add_u32 v13, s31, v13
    v_lshlrev_b32 v5, 4, v1
    s_lshl_b32 s38, s38, 2
    s_add_u32 s38, s38, s20
    s_mul_i32 s40, s38, 52
    s_lshr_b32 s40, s40, 8
    s_mul_i32 s41, s40, 5
    s_sub_u32 s41, s38, s41
    s_mul_i32 s40, s40, 48
    s_mul_i32 s37, s37, 6
    s_add_u32 s40, s40, s37
    s_mul_i32 s40, s40, 5
    s_add_u32 s40, s40, s41
    s_lshl_b32 s40, s40, 10
    s_add_u32 s40, s40, 13107200
    s_waitcnt vmcnt(0)
    v_mov_b32 v14, 158744
    v_mov_b32 v15, 1
    s_mov_b64 exec, 1
    ds_add_u32 v14, v15
    s_mov_b64 exec, -1
    v_mov_b32 v14, 158744
    s_mov_b32 s59, 2097152
L_lw_22:
    ds_read_b32 v15, v14
    s_waitcnt lgkmcnt(0)
    v_readfirstlane_b32 s58, v15
    s_nop 0
    s_cmp_ge_u32 s58, 4
    s_cbranch_scc1 L_lwok_23
    s_sleep 1
    s_sub_u32 s59, s59, 1
    s_cmp_lg_u32 s59, 0
    s_cbranch_scc1 L_lw_22
L_lwok_23:
    ds_read_b64_tr_b16 v[16:17], v13 offset:0
    ds_read_b64_tr_b16 v[18:19], v13 offset:512
    ds_read_b64_tr_b16 v[20:21], v13 offset:4096
    ds_read_b64_tr_b16 v[22:23], v13 offset:4608
    ds_read_b64_tr_b16 v[24:25], v13 offset:8192
    ds_read_b64_tr_b16 v[26:27], v13 offset:8704
    ds_read_b64_tr_b16 v[28:29], v13 offset:12288
    ds_read_b64_tr_b16 v[30:31], v13 offset:12800
    ds_read_b64_tr_b16 v[32:33], v13 offset:16384
    ds_read_b64_tr_b16 v[34:35], v13 offset:16896
    ds_read_b64_tr_b16 v[36:37], v13 offset:20480
    ds_read_b64_tr_b16 v[38:39], v13 offset:20992
    s_waitcnt lgkmcnt(10)
    buffer_store_dwordx4 v[16:19], v5, s[8:11], s40 offen sc1
    s_add_u32 s40, s40, 5120
    s_waitcnt lgkmcnt(8)
    buffer_store_dwordx4 v[20:23], v5, s[8:11], s40 offen sc1
    s_add_u32 s40, s40, 5120
    s_waitcnt lgkmcnt(6)
    buffer_store_dwordx4 v[24:27], v5, s[8:11], s40 offen sc1
    s_add_u32 s40, s40, 5120
    s_waitcnt lgkmcnt(4)
    buffer_store_dwordx4 v[28:31], v5, s[8:11], s40 offen sc1
    s_add_u32 s40, s40, 5120
    s_waitcnt lgkmcnt(2)
    buffer_store_dwordx4 v[32:35], v5, s[8:11], s40 offen sc1
    s_add_u32 s40, s40, 5120
    s_waitcnt lgkmcnt(0)
    buffer_store_dwordx4 v[36:39], v5, s[8:11], s40 offen sc1
    s_waitcnt vmcnt(0)
    v_mov_b32 v14, 158760
    v_mov_b32 v15, 1
    s_mov_b64 exec, 1
    ds_add_rtn_u32 v15, v14, v15
    s_mov_b64 exec, -1
    s_waitcnt lgkmcnt(0)
    v_readfirstlane_b32 s57, v15
    s_nop 0
    s_cmp_lg_u32 s57, 3
    s_cbranch_scc1 L_notlast_24
    v_mov_b32 v14, 0
    v_mov_b32 v15, s18
    s_mov_b64 exec, 1
    buffer_store_dword v15, v14, s[8:11], s36 offen sc1
    s_mov_b64 exec, -1
L_notlast_24:
    s_branch L_cdone_5
L_nof2_15:
    v_mov_b32 v14, 158760
    v_mov_b32 v15, 1
    s_mov_b64 exec, 1
    ds_add_u32 v14, v15
    s_mov_b64 exec, -1
L_cdone_5:
    s_and_b32 s26, s20, 1
    s_lshr_b32 s27, s20, 1
    s_mul_i32 s28, s26, 6144
    v_lshl_add_u32 v2, v1, 4, s28
    v_add_u32 v3, 61440, v2
    v_bfe_u32 v10, v1, 2, 2
    v_lshrrev_b32 v11, 4, v1
    v_lshl_add_u32 v8, v11, 3, v10
    v_lshlrev_b32 v8, 8, v8
    v_and_b32 v9, 3, v1
    v_lshl_add_u32 v8, v9, 3, v8
    v_add_u32 v8, 86016, v8
    v_and_b32 v9, 1, v11
    v_lshl_add_u32 v10, v9, 2, v10
    s_lshl_b32 s28, s27, 2
    v_xor_b32 v10, s28, v10
    v_xor_b32 v12, 0, v10
    v_lshl_add_u32 v4, v12, 5, v8
    v_xor_b32 v12, 1, v10
    v_lshl_add_u32 v5, v12, 5, v8
    v_xor_b32 v12, 2, v10
    v_lshl_add_u32 v6, v12, 5, v8
    v_xor_b32 v12, 3, v10
    v_lshl_add_u32 v7, v12, 5, v8
    v_and_b32 v15, 15, v1
    s_lshl_b32 s28, s27, 6
    v_add_u32 v10, s28, v15
    v_lshlrev_b32 v12, 4, v10
    v_add_u32 v12, 155648, v12
    s_mul_i32 s28, s26, 384
    s_add_u32 s28, s28, 143360
    v_lshl_add_u32 v13, v11, 4, s28
    v_mul_u32_u24 v14, 49152, v9
    v_lshrrev_b32 v10, 1, v11
    v_lshl_add_u32 v14, v10, 8, v14
    v_lshl_add_u32 v14, v15, 4, v14
    s_lshl_b32 s28, s21, 3
    s_lshl_b32 s29, s27, 2
    s_add_u32 s28, s28, s29
    s_mul_i32 s28, s28, 49152
    s_mul_i32 s29, s22, 6
    s_mul_i32 s30, s26, 3
    s_add_u32 s29, s29, s30
    s_lshl_b32 s29, s29, 9
    s_add_u32 s28, s28, s29
    s_add_u32 s28, s28, 15204352
    s_add_u32 s29, s28, 98304
    s_lshl_b32 s36, s21, 4
    s_add_u32 s36, s36, s22
    s_lshl_b32 s36, s36, 6
    s_add_u32 s36, s36, 32768
    s_barrier
    ds_read_b128 v[128:131], v2 offset:0
    ds_read_b64_tr_b16 v[152:153], v4 offset:0
    ds_read_b64_tr_b16 v[154:155], v4 offset:1024
    ds_read_b128 v[140:143], v2 offset:3072
    ds_read_b64_tr_b16 v[156:157], v5 offset:0
    ds_read_b64_tr_b16 v[158:159], v5 offset:1024
    ds_read_b64_tr_b16 v[160:161], v6 offset:0
    ds_read_b64_tr_b16 v[162:163], v6 offset:1024
    ds_read_b64_tr_b16 v[164:165], v7 offset:0
    ds_read_b64_tr_b16 v[166:167], v7 offset:1024
    ds_read_b128 v[132:135], v2 offset:1024
    ds_read_b128 v[144:147], v2 offset:4096
    ds_read_b128 v[136:139], v2 offset:2048
    ds_read_b128 v[148:151], v2 offset:5120
    s_waitcnt lgkmcnt(0)
    s_barrier
    v_mfma_f32_16x16x32_bf16 v[32:35], v[128:131], v[152:155], 0
    ds_read_b128 v[168:171], v2 offset:12288
    v_mfma_f32_16x16x32_bf16 v[80:83], v[140:143], v[152:155], 0
    ds_read_b64_tr_b16 v[192:193], v4 offset:8192
    v_mfma_f32_16x16x32_bf16 v[36:39], v[128:131], v[156:159], 0
    ds_read_b64_tr_b16 v[194:195], v4 offset:9216
    v_mfma_f32_16x16x32_bf16 v[84:87], v[140:143], v[156:159], 0
    ds_read_b128 v[180:183], v2 offset:15360
    v_mfma_f32_16x16x32_bf16 v[40:43], v[128:131], v[160:163], 0
    ds_read_b64_tr_b16 v[196:197], v5 offset:8192
    v_mfma_f32_16x16x32_bf16 v[88:91], v[140:143], v[160:163], 0
    ds_read_b64_tr_b16 v[198:199], v5 offset:9216
    v_mfma_f32_16x16x32_bf16 v[44:47], v[128:131], v[164:167], 0
    ds_read_b64_tr_b16 v[200:201], v6 offset:8192
    v_mfma_f32_16x16x32_bf16 v[92:95], v[140:143], v[164:167], 0
    ds_read_b64_tr_b16 v[202:203], v6 offset:9216
    v_mfma_f32_16x16x32_bf16 v[48:51], v[132:135], v[152:155], 0
    ds_read_b64_tr_b16 v[204:205], v7 offset:8192
    v_mfma_f32_16x16x32_bf16 v[96:99], v[144:147], v[152:155], 0
    ds_read_b64_tr_b16 v[206:207], v7 offset:9216
    v_mfma_f32_16x16x32_bf16 v[52:55], v[132:135], v[156:159], 0
    ds_read_b128 v[172:175], v2 offset:13312
    v_mfma_f32_16x16x32_bf16 v[100:103], v[144:147], v[156:159], 0
    ds_read_b128 v[184:187], v2 offset:16384
    v_mfma_f32_16x16x32_bf16 v[56:59], v[132:135], v[160:163], 0
    ds_read_b128 v[176:179], v2 offset:14336
    v_mfma_f32_16x16x32_bf16 v[104:107], v[144:147], v[160:163], 0
    ds_read_b128 v[188:191], v2 offset:17408
    v_mfma_f32_16x16x32_bf16 v[60:63], v[132:135], v[164:167], 0
    v_mfma_f32_16x16x32_bf16 v[108:111], v[144:147], v[164:167], 0
    v_mfma_f32_16x16x32_bf16 v[64:67], v[136:139], v[152:155], 0
    v_mfma_f32_16x16x32_bf16 v[112:115], v[148:151], v[152:155], 0
    v_mfma_f32_16x16x32_bf16 v[68:71], v[136:139], v[156:159], 0
    v_mfma_f32_16x16x32_bf16 v[116:119], v[148:151], v[156:159], 0
    v_mfma_f32_16x16x32_bf16 v[72:75], v[136:139], v[160:163], 0
    v_mfma_f32_16x16x32_bf16 v[120:123], v[148:151], v[160:163], 0
    v_mfma_f32_16x16x32_bf16 v[76:79], v[136:139], v[164:167], 0
    v_mfma_f32_16x16x32_bf16 v[124:127], v[148:151], v[164:167], 0
    s_waitcnt lgkmcnt(0)
    s_barrier
    v_mfma_f32_16x16x32_bf16 v[32:35], v[168:171], v[192:195], v[32:35]
    ds_read_b128 v[128:131], v2 offset:24576
    v_mfma_f32_16x16x32_bf16 v[80:83], v[180:183], v[192:195], v[80:83]
    ds_read_b64_tr_b16 v[152:153], v4 offset:16384
    v_mfma_f32_16x16x32_bf16 v[36:39], v[168:171], v[196:199], v[36:39]
    ds_read_b64_tr_b16 v[154:155], v4 offset:17408
    v_mfma_f32_16x16x32_bf16 v[84:87], v[180:183], v[196:199], v[84:87]
    ds_read_b128 v[140:143], v2 offset:27648
    v_mfma_f32_16x16x32_bf16 v[40:43], v[168:171], v[200:203], v[40:43]
    ds_read_b64_tr_b16 v[156:157], v5 offset:16384
    v_mfma_f32_16x16x32_bf16 v[88:91], v[180:183], v[200:203], v[88:91]
    ds_read_b64_tr_b16 v[158:159], v5 offset:17408
    v_mfma_f32_16x16x32_bf16 v[44:47], v[168:171], v[204:207], v[44:47]
    ds_read_b64_tr_b16 v[160:161], v6 offset:16384
    v_mfma_f32_16x16x32_bf16 v[92:95], v[180:183], v[204:207], v[92:95]
    ds_read_b64_tr_b16 v[162:163], v6 offset:17408
    v_mfma_f32_16x16x32_bf16 v[48:51], v[172:175], v[192:195], v[48:51]
    ds_read_b64_tr_b16 v[164:165], v7 offset:16384
    v_mfma_f32_16x16x32_bf16 v[96:99], v[184:187], v[192:195], v[96:99]
    ds_read_b64_tr_b16 v[166:167], v7 offset:17408
    v_mfma_f32_16x16x32_bf16 v[52:55], v[172:175], v[196:199], v[52:55]
    ds_read_b128 v[132:135], v2 offset:25600
    v_mfma_f32_16x16x32_bf16 v[100:103], v[184:187], v[196:199], v[100:103]
    ds_read_b128 v[144:147], v2 offset:28672
    v_mfma_f32_16x16x32_bf16 v[56:59], v[172:175], v[200:203], v[56:59]
    ds_read_b128 v[136:139], v2 offset:26624
    v_mfma_f32_16x16x32_bf16 v[104:107], v[184:187], v[200:203], v[104:107]
    ds_read_b128 v[148:151], v2 offset:29696
    v_mfma_f32_16x16x32_bf16 v[60:63], v[172:175], v[204:207], v[60:63]
    v_mfma_f32_16x16x32_bf16 v[108:111], v[184:187], v[204:207], v[108:111]
    v_mfma_f32_16x16x32_bf16 v[64:67], v[176:179], v[192:195], v[64:67]
    v_mfma_f32_16x16x32_bf16 v[112:115], v[188:191], v[192:195], v[112:115]
    v_mfma_f32_16x16x32_bf16 v[68:71], v[176:179], v[196:199], v[68:71]
    v_mfma_f32_16x16x32_bf16 v[116:119], v[188:191], v[196:199], v[116:119]
    v_mfma_f32_16x16x32_bf16 v[72:75], v[176:179], v[200:203], v[72:75]
    v_mfma_f32_16x16x32_bf16 v[120:123], v[188:191], v[200:203], v[120:123]
    v_mfma_f32_16x16x32_bf16 v[76:79], v[176:179], v[204:207], v[76:79]
    v_mfma_f32_16x16x32_bf16 v[124:127], v[188:191], v[204:207], v[124:127]
    s_waitcnt lgkmcnt(0)
    s_barrier
    v_mfma_f32_16x16x32_bf16 v[32:35], v[128:131], v[152:155], v[32:35]
    ds_read_b128 v[168:171], v2 offset:36864
    v_mfma_f32_16x16x32_bf16 v[80:83], v[140:143], v[152:155], v[80:83]
    ds_read_b64_tr_b16 v[192:193], v4 offset:24576
    v_mfma_f32_16x16x32_bf16 v[36:39], v[128:131], v[156:159], v[36:39]
    ds_read_b64_tr_b16 v[194:195], v4 offset:25600
    v_mfma_f32_16x16x32_bf16 v[84:87], v[140:143], v[156:159], v[84:87]
    ds_read_b128 v[180:183], v2 offset:39936
    v_mfma_f32_16x16x32_bf16 v[40:43], v[128:131], v[160:163], v[40:43]
    ds_read_b64_tr_b16 v[196:197], v5 offset:24576
    v_mfma_f32_16x16x32_bf16 v[88:91], v[140:143], v[160:163], v[88:91]
    ds_read_b64_tr_b16 v[198:199], v5 offset:25600
    v_mfma_f32_16x16x32_bf16 v[44:47], v[128:131], v[164:167], v[44:47]
    ds_read_b64_tr_b16 v[200:201], v6 offset:24576
    v_mfma_f32_16x16x32_bf16 v[92:95], v[140:143], v[164:167], v[92:95]
    ds_read_b64_tr_b16 v[202:203], v6 offset:25600
    v_mfma_f32_16x16x32_bf16 v[48:51], v[132:135], v[152:155], v[48:51]
    ds_read_b64_tr_b16 v[204:205], v7 offset:24576
    v_mfma_f32_16x16x32_bf16 v[96:99], v[144:147], v[152:155], v[96:99]
    ds_read_b64_tr_b16 v[206:207], v7 offset:25600
    v_mfma_f32_16x16x32_bf16 v[52:55], v[132:135], v[156:159], v[52:55]
    ds_read_b128 v[172:175], v2 offset:37888
    v_mfma_f32_16x16x32_bf16 v[100:103], v[144:147], v[156:159], v[100:103]
    ds_read_b128 v[184:187], v2 offset:40960
    v_mfma_f32_16x16x32_bf16 v[56:59], v[132:135], v[160:163], v[56:59]
    ds_read_b128 v[176:179], v2 offset:38912
    v_mfma_f32_16x16x32_bf16 v[104:107], v[144:147], v[160:163], v[104:107]
    ds_read_b128 v[188:191], v2 offset:41984
    v_mfma_f32_16x16x32_bf16 v[60:63], v[132:135], v[164:167], v[60:63]
    v_mfma_f32_16x16x32_bf16 v[108:111], v[144:147], v[164:167], v[108:111]
    v_mfma_f32_16x16x32_bf16 v[64:67], v[136:139], v[152:155], v[64:67]
    v_mfma_f32_16x16x32_bf16 v[112:115], v[148:151], v[152:155], v[112:115]
    v_mfma_f32_16x16x32_bf16 v[68:71], v[136:139], v[156:159], v[68:71]
    v_mfma_f32_16x16x32_bf16 v[116:119], v[148:151], v[156:159], v[116:119]
    v_mfma_f32_16x16x32_bf16 v[72:75], v[136:139], v[160:163], v[72:75]
    v_mfma_f32_16x16x32_bf16 v[120:123], v[148:151], v[160:163], v[120:123]
    v_mfma_f32_16x16x32_bf16 v[76:79], v[136:139], v[164:167], v[76:79]
    v_mfma_f32_16x16x32_bf16 v[124:127], v[148:151], v[164:167], v[124:127]
    s_waitcnt lgkmcnt(0)
    s_barrier
    v_mfma_f32_16x16x32_bf16 v[32:35], v[168:171], v[192:195], v[32:35]
    ds_read_b128 v[128:131], v2 offset:49152
    v_mfma_f32_16x16x32_bf16 v[80:83], v[180:183], v[192:195], v[80:83]
    ds_read_b64_tr_b16 v[152:153], v4 offset:32768
    v_mfma_f32_16x16x32_bf16 v[36:39], v[168:171], v[196:199], v[36:39]
    ds_read_b64_tr_b16 v[154:155], v4 offset:33792
    v_mfma_f32_16x16x32_bf16 v[84:87], v[180:183], v[196:199], v[84:87]
    ds_read_b128 v[140:143], v2 offset:52224
    v_mfma_f32_16x16x32_bf16 v[40:43], v[168:171], v[200:203], v[40:43]
    ds_read_b64_tr_b16 v[156:157], v5 offset:32768
    v_mfma_f32_16x16x32_bf16 v[88:91], v[180:183], v[200:203], v[88:91]
    ds_read_b64_tr_b16 v[158:159], v5 offset:33792
    v_mfma_f32_16x16x32_bf16 v[44:47], v[168:171], v[204:207], v[44:47]
    ds_read_b64_tr_b16 v[160:161], v6 offset:32768
    v_mfma_f32_16x16x32_bf16 v[92:95], v[180:183], v[204:207], v[92:95]
    ds_read_b64_tr_b16 v[162:163], v6 offset:33792
    v_mfma_f32_16x16x32_bf16 v[48:51], v[172:175], v[192:195], v[48:51]
    ds_read_b64_tr_b16 v[164:165], v7 offset:32768
    v_mfma_f32_16x16x32_bf16 v[96:99], v[184:187], v[192:195], v[96:99]
    ds_read_b64_tr_b16 v[166:167], v7 offset:33792
    v_mfma_f32_16x16x32_bf16 v[52:55], v[172:175], v[196:199], v[52:55]
    ds_read_b128 v[132:135], v2 offset:50176
    v_mfma_f32_16x16x32_bf16 v[100:103], v[184:187], v[196:199], v[100:103]
    ds_read_b128 v[144:147], v2 offset:53248
    v_mfma_f32_16x16x32_bf16 v[56:59], v[172:175], v[200:203], v[56:59]
    ds_read_b128 v[136:139], v2 offset:51200
    v_mfma_f32_16x16x32_bf16 v[104:107], v[184:187], v[200:203], v[104:107]
    ds_read_b128 v[148:151], v2 offset:54272
    v_mfma_f32_16x16x32_bf16 v[60:63], v[172:175], v[204:207], v[60:63]
    v_mfma_f32_16x16x32_bf16 v[108:111], v[184:187], v[204:207], v[108:111]
    v_mfma_f32_16x16x32_bf16 v[64:67], v[176:179], v[192:195], v[64:67]
    v_mfma_f32_16x16x32_bf16 v[112:115], v[188:191], v[192:195], v[112:115]
    v_mfma_f32_16x16x32_bf16 v[68:71], v[176:179], v[196:199], v[68:71]
    v_mfma_f32_16x16x32_bf16 v[116:119], v[188:191], v[196:199], v[116:119]
    v_mfma_f32_16x16x32_bf16 v[72:75], v[176:179], v[200:203], v[72:75]
    v_mfma_f32_16x16x32_bf16 v[120:123], v[188:191], v[200:203], v[120:123]
    v_mfma_f32_16x16x32_bf16 v[76:79], v[176:179], v[204:207], v[76:79]
    v_mfma_f32_16x16x32_bf16 v[124:127], v[188:191], v[204:207], v[124:127]
    s_waitcnt lgkmcnt(0)
    s_barrier
    v_mfma_f32_16x16x32_bf16 v[32:35], v[128:131], v[152:155], v[32:35]
    ds_read_b128 v[168:171], v3 offset:0
    v_mfma_f32_16x16x32_bf16 v[80:83], v[140:143], v[152:155], v[80:83]
    ds_read_b64_tr_b16 v[192:193], v4 offset:40960
    v_mfma_f32_16x16x32_bf16 v[36:39], v[128:131], v[156:159], v[36:39]
    ds_read_b64_tr_b16 v[194:195], v4 offset:41984
    v_mfma_f32_16x16x32_bf16 v[84:87], v[140:143], v[156:159], v[84:87]
    ds_read_b128 v[180:183], v3 offset:3072
    v_mfma_f32_16x16x32_bf16 v[40:43], v[128:131], v[160:163], v[40:43]
    ds_read_b64_tr_b16 v[196:197], v5 offset:40960
    v_mfma_f32_16x16x32_bf16 v[88:91], v[140:143], v[160:163], v[88:91]
    ds_read_b64_tr_b16 v[198:199], v5 offset:41984
    v_mfma_f32_16x16x32_bf16 v[44:47], v[128:131], v[164:167], v[44:47]
    ds_read_b64_tr_b16 v[200:201], v6 offset:40960
    v_mfma_f32_16x16x32_bf16 v[92:95], v[140:143], v[164:167], v[92:95]
    ds_read_b64_tr_b16 v[202:203], v6 offset:41984
    v_mfma_f32_16x16x32_bf16 v[48:51], v[132:135], v[152:155], v[48:51]
    ds_read_b64_tr_b16 v[204:205], v7 offset:40960
    v_mfma_f32_16x16x32_bf16 v[96:99], v[144:147], v[152:155], v[96:99]
    ds_read_b64_tr_b16 v[206:207], v7 offset:41984
    v_mfma_f32_16x16x32_bf16 v[52:55], v[132:135], v[156:159], v[52:55]
    ds_read_b128 v[172:175], v3 offset:1024
    v_mfma_f32_16x16x32_bf16 v[100:103], v[144:147], v[156:159], v[100:103]
    ds_read_b128 v[184:187], v3 offset:4096
    v_mfma_f32_16x16x32_bf16 v[56:59], v[132:135], v[160:163], v[56:59]
    ds_read_b128 v[176:179], v3 offset:2048
    v_mfma_f32_16x16x32_bf16 v[104:107], v[144:147], v[160:163], v[104:107]
    ds_read_b128 v[188:191], v3 offset:5120
    v_mfma_f32_16x16x32_bf16 v[60:63], v[132:135], v[164:167], v[60:63]
    v_mfma_f32_16x16x32_bf16 v[108:111], v[144:147], v[164:167], v[108:111]
    v_mfma_f32_16x16x32_bf16 v[64:67], v[136:139], v[152:155], v[64:67]
    v_mfma_f32_16x16x32_bf16 v[112:115], v[148:151], v[152:155], v[112:115]
    v_mfma_f32_16x16x32_bf16 v[68:71], v[136:139], v[156:159], v[68:71]
    v_mfma_f32_16x16x32_bf16 v[116:119], v[148:151], v[156:159], v[116:119]
    v_mfma_f32_16x16x32_bf16 v[72:75], v[136:139], v[160:163], v[72:75]
    v_mfma_f32_16x16x32_bf16 v[120:123], v[148:151], v[160:163], v[120:123]
    v_mfma_f32_16x16x32_bf16 v[76:79], v[136:139], v[164:167], v[76:79]
    v_mfma_f32_16x16x32_bf16 v[124:127], v[148:151], v[164:167], v[124:127]
    s_waitcnt lgkmcnt(0)
    s_barrier
    v_mfma_f32_16x16x32_bf16 v[32:35], v[168:171], v[192:195], v[32:35]
    ds_read_b128 v[128:131], v3 offset:12288
    v_mfma_f32_16x16x32_bf16 v[80:83], v[180:183], v[192:195], v[80:83]
    ds_read_b64_tr_b16 v[152:153], v4 offset:49152
    v_mfma_f32_16x16x32_bf16 v[36:39], v[168:171], v[196:199], v[36:39]
    ds_read_b64_tr_b16 v[154:155], v4 offset:50176
    v_mfma_f32_16x16x32_bf16 v[84:87], v[180:183], v[196:199], v[84:87]
    ds_read_b128 v[140:143], v3 offset:15360
    v_mfma_f32_16x16x32_bf16 v[40:43], v[168:171], v[200:203], v[40:43]
    ds_read_b64_tr_b16 v[156:157], v5 offset:49152
    v_mfma_f32_16x16x32_bf16 v[88:91], v[180:183], v[200:203], v[88:91]
    ds_read_b64_tr_b16 v[158:159], v5 offset:50176
    v_mfma_f32_16x16x32_bf16 v[44:47], v[168:171], v[204:207], v[44:47]
    ds_read_b64_tr_b16 v[160:161], v6 offset:49152
    v_mfma_f32_16x16x32_bf16 v[92:95], v[180:183], v[204:207], v[92:95]
    ds_read_b64_tr_b16 v[162:163], v6 offset:50176
    v_mfma_f32_16x16x32_bf16 v[48:51], v[172:175], v[192:195], v[48:51]
    ds_read_b64_tr_b16 v[164:165], v7 offset:49152
    v_mfma_f32_16x16x32_bf16 v[96:99], v[184:187], v[192:195], v[96:99]
    ds_read_b64_tr_b16 v[166:167], v7 offset:50176
    v_mfma_f32_16x16x32_bf16 v[52:55], v[172:175], v[196:199], v[52:55]
    ds_read_b128 v[132:135], v3 offset:13312
    v_mfma_f32_16x16x32_bf16 v[100:103], v[184:187], v[196:199], v[100:103]
    ds_read_b128 v[144:147], v3 offset:16384
    v_mfma_f32_16x16x32_bf16 v[56:59], v[172:175], v[200:203], v[56:59]
    ds_read_b128 v[136:139], v3 offset:14336
    v_mfma_f32_16x16x32_bf16 v[104:107], v[184:187], v[200:203], v[104:107]
    ds_read_b128 v[148:151], v3 offset:17408
    v_mfma_f32_16x16x32_bf16 v[60:63], v[172:175], v[204:207], v[60:63]
    v_mfma_f32_16x16x32_bf16 v[108:111], v[184:187], v[204:207], v[108:111]
    v_mfma_f32_16x16x32_bf16 v[64:67], v[176:179], v[192:195], v[64:67]
    v_mfma_f32_16x16x32_bf16 v[112:115], v[188:191], v[192:195], v[112:115]
    v_mfma_f32_16x16x32_bf16 v[68:71], v[176:179], v[196:199], v[68:71]
    v_mfma_f32_16x16x32_bf16 v[116:119], v[188:191], v[196:199], v[116:119]
    v_mfma_f32_16x16x32_bf16 v[72:75], v[176:179], v[200:203], v[72:75]
    v_mfma_f32_16x16x32_bf16 v[120:123], v[188:191], v[200:203], v[120:123]
    v_mfma_f32_16x16x32_bf16 v[76:79], v[176:179], v[204:207], v[76:79]
    v_mfma_f32_16x16x32_bf16 v[124:127], v[188:191], v[204:207], v[124:127]
    s_waitcnt lgkmcnt(0)
    s_barrier
    v_mfma_f32_16x16x32_bf16 v[32:35], v[128:131], v[152:155], v[32:35]
    ds_read_b128 v[168:171], v2 offset:0
    v_mfma_f32_16x16x32_bf16 v[80:83], v[140:143], v[152:155], v[80:83]
    ds_read_b64_tr_b16 v[192:193], v4 offset:0
    v_mfma_f32_16x16x32_bf16 v[36:39], v[128:131], v[156:159], v[36:39]
    ds_read_b64_tr_b16 v[194:195], v4 offset:1024
    v_mfma_f32_16x16x32_bf16 v[84:87], v[140:143], v[156:159], v[84:87]
    ds_read_b128 v[180:183], v2 offset:3072
    v_mfma_f32_16x16x32_bf16 v[40:43], v[128:131], v[160:163], v[40:43]
    ds_read_b64_tr_b16 v[196:197], v5 offset:0
    v_mfma_f32_16x16x32_bf16 v[88:91], v[140:143], v[160:163], v[88:91]
    ds_read_b64_tr_b16 v[198:199], v5 offset:1024
    v_mfma_f32_16x16x32_bf16 v[44:47], v[128:131], v[164:167], v[44:47]
    ds_read_b64_tr_b16 v[200:201], v6 offset:0
    v_mfma_f32_16x16x32_bf16 v[92:95], v[140:143], v[164:167], v[92:95]
    ds_read_b64_tr_b16 v[202:203], v6 offset:1024
    v_mfma_f32_16x16x32_bf16 v[48:51], v[132:135], v[152:155], v[48:51]
    ds_read_b64_tr_b16 v[204:205], v7 offset:0
    v_mfma_f32_16x16x32_bf16 v[96:99], v[144:147], v[152:155], v[96:99]
    ds_read_b64_tr_b16 v[206:207], v7 offset:1024
    v_mfma_f32_16x16x32_bf16 v[52:55], v[132:135], v[156:159], v[52:55]
    ds_read_b128 v[172:175], v2 offset:1024
    v_mfma_f32_16x16x32_bf16 v[100:103], v[144:147], v[156:159], v[100:103]
    ds_read_b128 v[184:187], v2 offset:4096
    v_mfma_f32_16x16x32_bf16 v[56:59], v[132:135], v[160:163], v[56:59]
    ds_read_b128 v[176:179], v2 offset:2048
    v_mfma_f32_16x16x32_bf16 v[104:107], v[144:147], v[160:163], v[104:107]
    ds_read_b128 v[188:191], v2 offset:5120
    v_mfma_f32_16x16x32_bf16 v[60:63], v[132:135], v[164:167], v[60:63]
    v_mfma_f32_16x16x32_bf16 v[108:111], v[144:147], v[164:167], v[108:111]
    v_mfma_f32_16x16x32_bf16 v[64:67], v[136:139], v[152:155], v[64:67]
    v_mfma_f32_16x16x32_bf16 v[112:115], v[148:151], v[152:155], v[112:115]
    v_mfma_f32_16x16x32_bf16 v[68:71], v[136:139], v[156:159], v[68:71]
    v_mfma_f32_16x16x32_bf16 v[116:119], v[148:151], v[156:159], v[116:119]
    v_mfma_f32_16x16x32_bf16 v[72:75], v[136:139], v[160:163], v[72:75]
    v_mfma_f32_16x16x32_bf16 v[120:123], v[148:151], v[160:163], v[120:123]
    v_mfma_f32_16x16x32_bf16 v[76:79], v[136:139], v[164:167], v[76:79]
    v_mfma_f32_16x16x32_bf16 v[124:127], v[148:151], v[164:167], v[124:127]
    s_waitcnt lgkmcnt(0)
    s_barrier
    v_mfma_f32_16x16x32_bf16 v[32:35], v[168:171], v[192:195], v[32:35]
    ds_read_b128 v[128:131], v2 offset:12288
    v_mfma_f32_16x16x32_bf16 v[80:83], v[180:183], v[192:195], v[80:83]
    ds_read_b64_tr_b16 v[152:153], v4 offset:8192
    v_mfma_f32_16x16x32_bf16 v[36:39], v[168:171], v[196:199], v[36:39]
    ds_read_b64_tr_b16 v[154:155], v4 offset:9216
    v_mfma_f32_16x16x32_bf16 v[84:87], v[180:183], v[196:199], v[84:87]
    ds_read_b128 v[140:143], v2 offset:15360
    v_mfma_f32_16x16x32_bf16 v[40:43], v[168:171], v[200:203], v[40:43]
    ds_read_b64_tr_b16 v[156:157], v5 offset:8192
    v_mfma_f32_16x16x32_bf16 v[88:91], v[180:183], v[200:203], v[88:91]
    ds_read_b64_tr_b16 v[158:159], v5 offset:9216
    v_mfma_f32_16x16x32_bf16 v[44:47], v[168:171], v[204:207], v[44:47]
    ds_read_b64_tr_b16 v[160:161], v6 offset:8192
    v_mfma_f32_16x16x32_bf16 v[92:95], v[180:183], v[204:207], v[92:95]
    ds_read_b64_tr_b16 v[162:163], v6 offset:9216
    v_mfma_f32_16x16x32_bf16 v[48:51], v[172:175], v[192:195], v[48:51]
    ds_read_b64_tr_b16 v[164:165], v7 offset:8192
    v_mfma_f32_16x16x32_bf16 v[96:99], v[184:187], v[192:195], v[96:99]
    ds_read_b64_tr_b16 v[166:167], v7 offset:9216
    v_mfma_f32_16x16x32_bf16 v[52:55], v[172:175], v[196:199], v[52:55]
    ds_read_b128 v[132:135], v2 offset:13312
    v_mfma_f32_16x16x32_bf16 v[100:103], v[184:187], v[196:199], v[100:103]
    ds_read_b128 v[144:147], v2 offset:16384
    v_mfma_f32_16x16x32_bf16 v[56:59], v[172:175], v[200:203], v[56:59]
    ds_read_b128 v[136:139], v2 offset:14336
    v_mfma_f32_16x16x32_bf16 v[104:107], v[184:187], v[200:203], v[104:107]
    ds_read_b128 v[148:151], v2 offset:17408
    v_mfma_f32_16x16x32_bf16 v[60:63], v[172:175], v[204:207], v[60:63]
    v_mfma_f32_16x16x32_bf16 v[108:111], v[184:187], v[204:207], v[108:111]
    v_mfma_f32_16x16x32_bf16 v[64:67], v[176:179], v[192:195], v[64:67]
    v_mfma_f32_16x16x32_bf16 v[112:115], v[188:191], v[192:195], v[112:115]
    v_mfma_f32_16x16x32_bf16 v[68:71], v[176:179], v[196:199], v[68:71]
    v_mfma_f32_16x16x32_bf16 v[116:119], v[188:191], v[196:199], v[116:119]
    v_mfma_f32_16x16x32_bf16 v[72:75], v[176:179], v[200:203], v[72:75]
    v_mfma_f32_16x16x32_bf16 v[120:123], v[188:191], v[200:203], v[120:123]
    v_mfma_f32_16x16x32_bf16 v[76:79], v[176:179], v[204:207], v[76:79]
    v_mfma_f32_16x16x32_bf16 v[124:127], v[188:191], v[204:207], v[124:127]
    s_waitcnt lgkmcnt(0)
    s_barrier
    v_mfma_f32_16x16x32_bf16 v[32:35], v[128:131], v[152:155], v[32:35]
    ds_read_b128 v[168:171], v2 offset:24576
    v_mfma_f32_16x16x32_bf16 v[80:83], v[140:143], v[152:155], v[80:83]
    ds_read_b64_tr_b16 v[192:193], v4 offset:16384
    v_mfma_f32_16x16x32_bf16 v[36:39], v[128:131], v[156:159], v[36:39]
    ds_read_b64_tr_b16 v[194:195], v4 offset:17408
    v_mfma_f32_16x16x32_bf16 v[84:87], v[140:143], v[156:159], v[84:87]
    ds_read_b128 v[180:183], v2 offset:27648
    v_mfma_f32_16x16x32_bf16 v[40:43], v[128:131], v[160:163], v[40:43]
    ds_read_b64_tr_b16 v[196:197], v5 offset:16384
    v_mfma_f32_16x16x32_bf16 v[88:91], v[140:143], v[160:163], v[88:91]
    ds_read_b64_tr_b16 v[198:199], v5 offset:17408
    v_mfma_f32_16x16x32_bf16 v[44:47], v[128:131], v[164:167], v[44:47]
    ds_read_b64_tr_b16 v[200:201], v6 offset:16384
    v_mfma_f32_16x16x32_bf16 v[92:95], v[140:143], v[164:167], v[92:95]
    ds_read_b64_tr_b16 v[202:203], v6 offset:17408
    v_mfma_f32_16x16x32_bf16 v[48:51], v[132:135], v[152:155], v[48:51]
    ds_read_b64_tr_b16 v[204:205], v7 offset:16384
    v_mfma_f32_16x16x32_bf16 v[96:99], v[144:147], v[152:155], v[96:99]
    ds_read_b64_tr_b16 v[206:207], v7 offset:17408
    v_mfma_f32_16x16x32_bf16 v[52:55], v[132:135], v[156:159], v[52:55]
    ds_read_b128 v[172:175], v2 offset:25600
    v_mfma_f32_16x16x32_bf16 v[100:103], v[144:147], v[156:159], v[100:103]
    ds_read_b128 v[184:187], v2 offset:28672
    v_mfma_f32_16x16x32_bf16 v[56:59], v[132:135], v[160:163], v[56:59]
    ds_read_b128 v[176:179], v2 offset:26624
    v_mfma_f32_16x16x32_bf16 v[104:107], v[144:147], v[160:163], v[104:107]
    ds_read_b128 v[188:191], v2 offset:29696
    v_mfma_f32_16x16x32_bf16 v[60:63], v[132:135], v[164:167], v[60:63]
    v_mfma_f32_16x16x32_bf16 v[108:111], v[144:147], v[164:167], v[108:111]
    v_mfma_f32_16x16x32_bf16 v[64:67], v[136:139], v[152:155], v[64:67]
    v_mfma_f32_16x16x32_bf16 v[112:115], v[148:151], v[152:155], v[112:115]
    v_mfma_f32_16x16x32_bf16 v[68:71], v[136:139], v[156:159], v[68:71]
    v_mfma_f32_16x16x32_bf16 v[116:119], v[148:151], v[156:159], v[116:119]
    v_mfma_f32_16x16x32_bf16 v[72:75], v[136:139], v[160:163], v[72:75]
    v_mfma_f32_16x16x32_bf16 v[120:123], v[148:151], v[160:163], v[120:123]
    v_mfma_f32_16x16x32_bf16 v[76:79], v[136:139], v[164:167], v[76:79]
    v_mfma_f32_16x16x32_bf16 v[124:127], v[148:151], v[164:167], v[124:127]
    s_waitcnt lgkmcnt(0)
    s_barrier
    v_mfma_f32_16x16x32_bf16 v[32:35], v[168:171], v[192:195], v[32:35]
    ds_read_b128 v[128:131], v2 offset:36864
    v_mfma_f32_16x16x32_bf16 v[80:83], v[180:183], v[192:195], v[80:83]
    ds_read_b64_tr_b16 v[152:153], v4 offset:24576
    v_mfma_f32_16x16x32_bf16 v[36:39], v[168:171], v[196:199], v[36:39]
    ds_read_b64_tr_b16 v[154:155], v4 offset:25600
    v_mfma_f32_16x16x32_bf16 v[84:87], v[180:183], v[196:199], v[84:87]
    ds_read_b128 v[140:143], v2 offset:39936
    v_mfma_f32_16x16x32_bf16 v[40:43], v[168:171], v[200:203], v[40:43]
    ds_read_b64_tr_b16 v[156:157], v5 offset:24576
    v_mfma_f32_16x16x32_bf16 v[88:91], v[180:183], v[200:203], v[88:91]
    ds_read_b64_tr_b16 v[158:159], v5 offset:25600
    v_mfma_f32_16x16x32_bf16 v[44:47], v[168:171], v[204:207], v[44:47]
    ds_read_b64_tr_b16 v[160:161], v6 offset:24576
    v_mfma_f32_16x16x32_bf16 v[92:95], v[180:183], v[204:207], v[92:95]
    ds_read_b64_tr_b16 v[162:163], v6 offset:25600
    v_mfma_f32_16x16x32_bf16 v[48:51], v[172:175], v[192:195], v[48:51]
    ds_read_b64_tr_b16 v[164:165], v7 offset:24576
    v_mfma_f32_16x16x32_bf16 v[96:99], v[184:187], v[192:195], v[96:99]
    ds_read_b64_tr_b16 v[166:167], v7 offset:25600
    v_mfma_f32_16x16x32_bf16 v[52:55], v[172:175], v[196:199], v[52:55]
    ds_read_b128 v[132:135], v2 offset:37888
    v_mfma_f32_16x16x32_bf16 v[100:103], v[184:187], v[196:199], v[100:103]
    ds_read_b128 v[144:147], v2 offset:40960
    v_mfma_f32_16x16x32_bf16 v[56:59], v[172:175], v[200:203], v[56:59]
    ds_read_b128 v[136:139], v2 offset:38912
    v_mfma_f32_16x16x32_bf16 v[104:107], v[184:187], v[200:203], v[104:107]
    ds_read_b128 v[148:151], v2 offset:41984
    v_mfma_f32_16x16x32_bf16 v[60:63], v[172:175], v[204:207], v[60:63]
    v_mfma_f32_16x16x32_bf16 v[108:111], v[184:187], v[204:207], v[108:111]
    v_mfma_f32_16x16x32_bf16 v[64:67], v[176:179], v[192:195], v[64:67]
    v_mfma_f32_16x16x32_bf16 v[112:115], v[188:191], v[192:195], v[112:115]
    v_mfma_f32_16x16x32_bf16 v[68:71], v[176:179], v[196:199], v[68:71]
    v_mfma_f32_16x16x32_bf16 v[116:119], v[188:191], v[196:199], v[116:119]
    v_mfma_f32_16x16x32_bf16 v[72:75], v[176:179], v[200:203], v[72:75]
    v_mfma_f32_16x16x32_bf16 v[120:123], v[188:191], v[200:203], v[120:123]
    v_mfma_f32_16x16x32_bf16 v[76:79], v[176:179], v[204:207], v[76:79]
    v_mfma_f32_16x16x32_bf16 v[124:127], v[188:191], v[204:207], v[124:127]
    s_waitcnt lgkmcnt(0)
    s_barrier
    v_mfma_f32_16x16x32_bf16 v[32:35], v[128:131], v[152:155], v[32:35]
    ds_read_b128 v[168:171], v2 offset:49152
    v_mfma_f32_16x16x32_bf16 v[80:83], v[140:143], v[152:155], v[80:83]
    ds_read_b64_tr_b16 v[192:193], v4 offset:32768
    v_mfma_f32_16x16x32_bf16 v[36:39], v[128:131], v[156:159], v[36:39]
    ds_read_b64_tr_b16 v[194:195], v4 offset:33792
    v_mfma_f32_16x16x32_bf16 v[84:87], v[140:143], v[156:159], v[84:87]
    ds_read_b128 v[180:183], v2 offset:52224
    v_mfma_f32_16x16x32_bf16 v[40:43], v[128:131], v[160:163], v[40:43]
    ds_read_b64_tr_b16 v[196:197], v5 offset:32768
    v_mfma_f32_16x16x32_bf16 v[88:91], v[140:143], v[160:163], v[88:91]
    ds_read_b64_tr_b16 v[198:199], v5 offset:33792
    v_mfma_f32_16x16x32_bf16 v[44:47], v[128:131], v[164:167], v[44:47]
    ds_read_b64_tr_b16 v[200:201], v6 offset:32768
    v_mfma_f32_16x16x32_bf16 v[92:95], v[140:143], v[164:167], v[92:95]
    ds_read_b64_tr_b16 v[202:203], v6 offset:33792
    v_mfma_f32_16x16x32_bf16 v[48:51], v[132:135], v[152:155], v[48:51]
    ds_read_b64_tr_b16 v[204:205], v7 offset:32768
    v_mfma_f32_16x16x32_bf16 v[96:99], v[144:147], v[152:155], v[96:99]
    ds_read_b64_tr_b16 v[206:207], v7 offset:33792
    v_mfma_f32_16x16x32_bf16 v[52:55], v[132:135], v[156:159], v[52:55]
    ds_read_b128 v[172:175], v2 offset:50176
    v_mfma_f32_16x16x32_bf16 v[100:103], v[144:147], v[156:159], v[100:103]
    ds_read_b128 v[184:187], v2 offset:53248
    v_mfma_f32_16x16x32_bf16 v[56:59], v[132:135], v[160:163], v[56:59]
    ds_read_b128 v[176:179], v2 offset:51200
    v_mfma_f32_16x16x32_bf16 v[104:107], v[144:147], v[160:163], v[104:107]
    ds_read_b128 v[188:191], v2 offset:54272
    v_mfma_f32_16x16x32_bf16 v[60:63], v[132:135], v[164:167], v[60:63]
    v_mfma_f32_16x16x32_bf16 v[108:111], v[144:147], v[164:167], v[108:111]
    v_mfma_f32_16x16x32_bf16 v[64:67], v[136:139], v[152:155], v[64:67]
    v_mfma_f32_16x16x32_bf16 v[112:115], v[148:151], v[152:155], v[112:115]
    v_mfma_f32_16x16x32_bf16 v[68:71], v[136:139], v[156:159], v[68:71]
    v_mfma_f32_16x16x32_bf16 v[116:119], v[148:151], v[156:159], v[116:119]
    v_mfma_f32_16x16x32_bf16 v[72:75], v[136:139], v[160:163], v[72:75]
    v_mfma_f32_16x16x32_bf16 v[120:123], v[148:151], v[160:163], v[120:123]
    v_mfma_f32_16x16x32_bf16 v[76:79], v[136:139], v[164:167], v[76:79]
    v_mfma_f32_16x16x32_bf16 v[124:127], v[148:151], v[164:167], v[124:127]
    s_waitcnt lgkmcnt(0)
    s_barrier
    v_mfma_f32_16x16x32_bf16 v[32:35], v[168:171], v[192:195], v[32:35]
    ds_read_b128 v[128:131], v3 offset:0
    v_mfma_f32_16x16x32_bf16 v[80:83], v[180:183], v[192:195], v[80:83]
    ds_read_b64_tr_b16 v[152:153], v4 offset:40960
    v_mfma_f32_16x16x32_bf16 v[36:39], v[168:171], v[196:199], v[36:39]
    ds_read_b64_tr_b16 v[154:155], v4 offset:41984
    v_mfma_f32_16x16x32_bf16 v[84:87], v[180:183], v[196:199], v[84:87]
    ds_read_b128 v[140:143], v3 offset:3072
    v_mfma_f32_16x16x32_bf16 v[40:43], v[168:171], v[200:203], v[40:43]
    ds_read_b64_tr_b16 v[156:157], v5 offset:40960
    v_mfma_f32_16x16x32_bf16 v[88:91], v[180:183], v[200:203], v[88:91]
    ds_read_b64_tr_b16 v[158:159], v5 offset:41984
    v_mfma_f32_16x16x32_bf16 v[44:47], v[168:171], v[204:207], v[44:47]
    ds_read_b64_tr_b16 v[160:161], v6 offset:40960
    v_mfma_f32_16x16x32_bf16 v[92:95], v[180:183], v[204:207], v[92:95]
    ds_read_b64_tr_b16 v[162:163], v6 offset:41984
    v_mfma_f32_16x16x32_bf16 v[48:51], v[172:175], v[192:195], v[48:51]
    ds_read_b64_tr_b16 v[164:165], v7 offset:40960
    v_mfma_f32_16x16x32_bf16 v[96:99], v[184:187], v[192:195], v[96:99]
    ds_read_b64_tr_b16 v[166:167], v7 offset:41984
    v_mfma_f32_16x16x32_bf16 v[52:55], v[172:175], v[196:199], v[52:55]
    ds_read_b128 v[132:135], v3 offset:1024
    v_mfma_f32_16x16x32_bf16 v[100:103], v[184:187], v[196:199], v[100:103]
    ds_read_b128 v[144:147], v3 offset:4096
    v_mfma_f32_16x16x32_bf16 v[56:59], v[172:175], v[200:203], v[56:59]
    ds_read_b128 v[136:139], v3 offset:2048
    v_mfma_f32_16x16x32_bf16 v[104:107], v[184:187], v[200:203], v[104:107]
    ds_read_b128 v[148:151], v3 offset:5120
    v_mfma_f32_16x16x32_bf16 v[60:63], v[172:175], v[204:207], v[60:63]
    v_mfma_f32_16x16x32_bf16 v[108:111], v[184:187], v[204:207], v[108:111]
    v_mfma_f32_16x16x32_bf16 v[64:67], v[176:179], v[192:195], v[64:67]
    v_mfma_f32_16x16x32_bf16 v[112:115], v[188:191], v[192:195], v[112:115]
    v_mfma_f32_16x16x32_bf16 v[68:71], v[176:179], v[196:199], v[68:71]
    v_mfma_f32_16x16x32_bf16 v[116:119], v[188:191], v[196:199], v[116:119]
    v_mfma_f32_16x16x32_bf16 v[72:75], v[176:179], v[200:203], v[72:75]
    v_mfma_f32_16x16x32_bf16 v[120:123], v[188:191], v[200:203], v[120:123]
    v_mfma_f32_16x16x32_bf16 v[76:79], v[176:179], v[204:207], v[76:79]
    v_mfma_f32_16x16x32_bf16 v[124:127], v[188:191], v[204:207], v[124:127]
    s_waitcnt lgkmcnt(0)
    s_barrier
    v_mfma_f32_16x16x32_bf16 v[32:35], v[128:131], v[152:155], v[32:35]
    ds_read_b128 v[168:171], v3 offset:12288
    v_mfma_f32_16x16x32_bf16 v[80:83], v[140:143], v[152:155], v[80:83]
    ds_read_b64_tr_b16 v[192:193], v4 offset:49152
    v_mfma_f32_16x16x32_bf16 v[36:39], v[128:131], v[156:159], v[36:39]
    ds_read_b64_tr_b16 v[194:195], v4 offset:50176
    v_mfma_f32_16x16x32_bf16 v[84:87], v[140:143], v[156:159], v[84:87]
    ds_read_b128 v[180:183], v3 offset:15360
    v_mfma_f32_16x16x32_bf16 v[40:43], v[128:131], v[160:163], v[40:43]
    ds_read_b64_tr_b16 v[196:197], v5 offset:49152
    v_mfma_f32_16x16x32_bf16 v[88:91], v[140:143], v[160:163], v[88:91]
    ds_read_b64_tr_b16 v[198:199], v5 offset:50176
    v_mfma_f32_16x16x32_bf16 v[44:47], v[128:131], v[164:167], v[44:47]
    ds_read_b64_tr_b16 v[200:201], v6 offset:49152
    v_mfma_f32_16x16x32_bf16 v[92:95], v[140:143], v[164:167], v[92:95]
    ds_read_b64_tr_b16 v[202:203], v6 offset:50176
    v_mfma_f32_16x16x32_bf16 v[48:51], v[132:135], v[152:155], v[48:51]
    ds_read_b64_tr_b16 v[204:205], v7 offset:49152
    v_mfma_f32_16x16x32_bf16 v[96:99], v[144:147], v[152:155], v[96:99]
    ds_read_b64_tr_b16 v[206:207], v7 offset:50176
    v_mfma_f32_16x16x32_bf16 v[52:55], v[132:135], v[156:159], v[52:55]
    ds_read_b128 v[172:175], v3 offset:13312
    v_mfma_f32_16x16x32_bf16 v[100:103], v[144:147], v[156:159], v[100:103]
    ds_read_b128 v[184:187], v3 offset:16384
    v_mfma_f32_16x16x32_bf16 v[56:59], v[132:135], v[160:163], v[56:59]
    ds_read_b128 v[176:179], v3 offset:14336
    v_mfma_f32_16x16x32_bf16 v[104:107], v[144:147], v[160:163], v[104:107]
    ds_read_b128 v[188:191], v3 offset:17408
    v_mfma_f32_16x16x32_bf16 v[60:63], v[132:135], v[164:167], v[60:63]
    v_mfma_f32_16x16x32_bf16 v[108:111], v[144:147], v[164:167], v[108:111]
    v_mfma_f32_16x16x32_bf16 v[64:67], v[136:139], v[152:155], v[64:67]
    v_mfma_f32_16x16x32_bf16 v[112:115], v[148:151], v[152:155], v[112:115]
    v_mfma_f32_16x16x32_bf16 v[68:71], v[136:139], v[156:159], v[68:71]
    v_mfma_f32_16x16x32_bf16 v[116:119], v[148:151], v[156:159], v[116:119]
    v_mfma_f32_16x16x32_bf16 v[72:75], v[136:139], v[160:163], v[72:75]
    v_mfma_f32_16x16x32_bf16 v[120:123], v[148:151], v[160:163], v[120:123]
    v_mfma_f32_16x16x32_bf16 v[76:79], v[136:139], v[164:167], v[76:79]
    v_mfma_f32_16x16x32_bf16 v[124:127], v[148:151], v[164:167], v[124:127]
    s_waitcnt lgkmcnt(0)
    s_barrier
    v_mfma_f32_16x16x32_bf16 v[32:35], v[168:171], v[192:195], v[32:35]
    ds_read_b128 v[128:131], v2 offset:0
    v_mfma_f32_16x16x32_bf16 v[80:83], v[180:183], v[192:195], v[80:83]
    ds_read_b64_tr_b16 v[152:153], v4 offset:0
    v_mfma_f32_16x16x32_bf16 v[36:39], v[168:171], v[196:199], v[36:39]
    ds_read_b64_tr_b16 v[154:155], v4 offset:1024
    v_mfma_f32_16x16x32_bf16 v[84:87], v[180:183], v[196:199], v[84:87]
    ds_read_b128 v[140:143], v2 offset:3072
    v_mfma_f32_16x16x32_bf16 v[40:43], v[168:171], v[200:203], v[40:43]
    ds_read_b64_tr_b16 v[156:157], v5 offset:0
    v_mfma_f32_16x16x32_bf16 v[88:91], v[180:183], v[200:203], v[88:91]
    ds_read_b64_tr_b16 v[158:159], v5 offset:1024
    v_mfma_f32_16x16x32_bf16 v[44:47], v[168:171], v[204:207], v[44:47]
    ds_read_b64_tr_b16 v[160:161], v6 offset:0
    v_mfma_f32_16x16x32_bf16 v[92:95], v[180:183], v[204:207], v[92:95]
    ds_read_b64_tr_b16 v[162:163], v6 offset:1024
    v_mfma_f32_16x16x32_bf16 v[48:51], v[172:175], v[192:195], v[48:51]
    ds_read_b64_tr_b16 v[164:165], v7 offset:0
    v_mfma_f32_16x16x32_bf16 v[96:99], v[184:187], v[192:195], v[96:99]
    ds_read_b64_tr_b16 v[166:167], v7 offset:1024
    v_mfma_f32_16x16x32_bf16 v[52:55], v[172:175], v[196:199], v[52:55]
    ds_read_b128 v[132:135], v2 offset:1024
    v_mfma_f32_16x16x32_bf16 v[100:103], v[184:187], v[196:199], v[100:103]
    ds_read_b128 v[144:147], v2 offset:4096
    v_mfma_f32_16x16x32_bf16 v[56:59], v[172:175], v[200:203], v[56:59]
    ds_read_b128 v[136:139], v2 offset:2048
    v_mfma_f32_16x16x32_bf16 v[104:107], v[184:187], v[200:203], v[104:107]
    ds_read_b128 v[148:151], v2 offset:5120
    v_mfma_f32_16x16x32_bf16 v[60:63], v[172:175], v[204:207], v[60:63]
    v_mfma_f32_16x16x32_bf16 v[108:111], v[184:187], v[204:207], v[108:111]
    v_mfma_f32_16x16x32_bf16 v[64:67], v[176:179], v[192:195], v[64:67]
    v_mfma_f32_16x16x32_bf16 v[112:115], v[188:191], v[192:195], v[112:115]
    v_mfma_f32_16x16x32_bf16 v[68:71], v[176:179], v[196:199], v[68:71]
    v_mfma_f32_16x16x32_bf16 v[116:119], v[188:191], v[196:199], v[116:119]
    v_mfma_f32_16x16x32_bf16 v[72:75], v[176:179], v[200:203], v[72:75]
    v_mfma_f32_16x16x32_bf16 v[120:123], v[188:191], v[200:203], v[120:123]
    v_mfma_f32_16x16x32_bf16 v[76:79], v[176:179], v[204:207], v[76:79]
    v_mfma_f32_16x16x32_bf16 v[124:127], v[188:191], v[204:207], v[124:127]
    s_waitcnt lgkmcnt(0)
    s_barrier
    v_mfma_f32_16x16x32_bf16 v[32:35], v[128:131], v[152:155], v[32:35]
    ds_read_b128 v[168:171], v2 offset:12288
    v_mfma_f32_16x16x32_bf16 v[80:83], v[140:143], v[152:155], v[80:83]
    ds_read_b64_tr_b16 v[192:193], v4 offset:8192
    v_mfma_f32_16x16x32_bf16 v[36:39], v[128:131], v[156:159], v[36:39]
    ds_read_b64_tr_b16 v[194:195], v4 offset:9216
    v_mfma_f32_16x16x32_bf16 v[84:87], v[140:143], v[156:159], v[84:87]
    ds_read_b128 v[180:183], v2 offset:15360
    v_mfma_f32_16x16x32_bf16 v[40:43], v[128:131], v[160:163], v[40:43]
    ds_read_b64_tr_b16 v[196:197], v5 offset:8192
    v_mfma_f32_16x16x32_bf16 v[88:91], v[140:143], v[160:163], v[88:91]
    ds_read_b64_tr_b16 v[198:199], v5 offset:9216
    v_mfma_f32_16x16x32_bf16 v[44:47], v[128:131], v[164:167], v[44:47]
    ds_read_b64_tr_b16 v[200:201], v6 offset:8192
    v_mfma_f32_16x16x32_bf16 v[92:95], v[140:143], v[164:167], v[92:95]
    ds_read_b64_tr_b16 v[202:203], v6 offset:9216
    v_mfma_f32_16x16x32_bf16 v[48:51], v[132:135], v[152:155], v[48:51]
    ds_read_b64_tr_b16 v[204:205], v7 offset:8192
    v_mfma_f32_16x16x32_bf16 v[96:99], v[144:147], v[152:155], v[96:99]
    ds_read_b64_tr_b16 v[206:207], v7 offset:9216
    v_mfma_f32_16x16x32_bf16 v[52:55], v[132:135], v[156:159], v[52:55]
    ds_read_b128 v[172:175], v2 offset:13312
    v_mfma_f32_16x16x32_bf16 v[100:103], v[144:147], v[156:159], v[100:103]
    ds_read_b128 v[184:187], v2 offset:16384
    v_mfma_f32_16x16x32_bf16 v[56:59], v[132:135], v[160:163], v[56:59]
    ds_read_b128 v[176:179], v2 offset:14336
    v_mfma_f32_16x16x32_bf16 v[104:107], v[144:147], v[160:163], v[104:107]
    ds_read_b128 v[188:191], v2 offset:17408
    v_mfma_f32_16x16x32_bf16 v[60:63], v[132:135], v[164:167], v[60:63]
    v_mfma_f32_16x16x32_bf16 v[108:111], v[144:147], v[164:167], v[108:111]
    v_mfma_f32_16x16x32_bf16 v[64:67], v[136:139], v[152:155], v[64:67]
    v_mfma_f32_16x16x32_bf16 v[112:115], v[148:151], v[152:155], v[112:115]
    v_mfma_f32_16x16x32_bf16 v[68:71], v[136:139], v[156:159], v[68:71]
    v_mfma_f32_16x16x32_bf16 v[116:119], v[148:151], v[156:159], v[116:119]
    v_mfma_f32_16x16x32_bf16 v[72:75], v[136:139], v[160:163], v[72:75]
    v_mfma_f32_16x16x32_bf16 v[120:123], v[148:151], v[160:163], v[120:123]
    v_mfma_f32_16x16x32_bf16 v[76:79], v[136:139], v[164:167], v[76:79]
    v_mfma_f32_16x16x32_bf16 v[124:127], v[148:151], v[164:167], v[124:127]
    s_waitcnt lgkmcnt(0)
    s_barrier
    v_mfma_f32_16x16x32_bf16 v[32:35], v[168:171], v[192:195], v[32:35]
    ds_read_b128 v[128:131], v2 offset:24576
    v_mfma_f32_16x16x32_bf16 v[80:83], v[180:183], v[192:195], v[80:83]
    ds_read_b64_tr_b16 v[152:153], v4 offset:16384
    v_mfma_f32_16x16x32_bf16 v[36:39], v[168:171], v[196:199], v[36:39]
    ds_read_b64_tr_b16 v[154:155], v4 offset:17408
    v_mfma_f32_16x16x32_bf16 v[84:87], v[180:183], v[196:199], v[84:87]
    ds_read_b128 v[140:143], v2 offset:27648
    v_mfma_f32_16x16x32_bf16 v[40:43], v[168:171], v[200:203], v[40:43]
    ds_read_b64_tr_b16 v[156:157], v5 offset:16384
    v_mfma_f32_16x16x32_bf16 v[88:91], v[180:183], v[200:203], v[88:91]
    ds_read_b64_tr_b16 v[158:159], v5 offset:17408
    v_mfma_f32_16x16x32_bf16 v[44:47], v[168:171], v[204:207], v[44:47]
    ds_read_b64_tr_b16 v[160:161], v6 offset:16384
    v_mfma_f32_16x16x32_bf16 v[92:95], v[180:183], v[204:207], v[92:95]
    ds_read_b64_tr_b16 v[162:163], v6 offset:17408
    v_mfma_f32_16x16x32_bf16 v[48:51], v[172:175], v[192:195], v[48:51]
    ds_read_b64_tr_b16 v[164:165], v7 offset:16384
    v_mfma_f32_16x16x32_bf16 v[96:99], v[184:187], v[192:195], v[96:99]
    ds_read_b64_tr_b16 v[166:167], v7 offset:17408
    v_mfma_f32_16x16x32_bf16 v[52:55], v[172:175], v[196:199], v[52:55]
    ds_read_b128 v[132:135], v2 offset:25600
    v_mfma_f32_16x16x32_bf16 v[100:103], v[184:187], v[196:199], v[100:103]
    ds_read_b128 v[144:147], v2 offset:28672
    v_mfma_f32_16x16x32_bf16 v[56:59], v[172:175], v[200:203], v[56:59]
    ds_read_b128 v[136:139], v2 offset:26624
    v_mfma_f32_16x16x32_bf16 v[104:107], v[184:187], v[200:203], v[104:107]
    ds_read_b128 v[148:151], v2 offset:29696
    v_mfma_f32_16x16x32_bf16 v[60:63], v[172:175], v[204:207], v[60:63]
    v_mfma_f32_16x16x32_bf16 v[108:111], v[184:187], v[204:207], v[108:111]
    v_mfma_f32_16x16x32_bf16 v[64:67], v[176:179], v[192:195], v[64:67]
    v_mfma_f32_16x16x32_bf16 v[112:115], v[188:191], v[192:195], v[112:115]
    v_mfma_f32_16x16x32_bf16 v[68:71], v[176:179], v[196:199], v[68:71]
    v_mfma_f32_16x16x32_bf16 v[116:119], v[188:191], v[196:199], v[116:119]
    v_mfma_f32_16x16x32_bf16 v[72:75], v[176:179], v[200:203], v[72:75]
    v_mfma_f32_16x16x32_bf16 v[120:123], v[188:191], v[200:203], v[120:123]
    v_mfma_f32_16x16x32_bf16 v[76:79], v[176:179], v[204:207], v[76:79]
    v_mfma_f32_16x16x32_bf16 v[124:127], v[188:191], v[204:207], v[124:127]
    s_waitcnt lgkmcnt(0)
    s_barrier
    v_mfma_f32_16x16x32_bf16 v[32:35], v[128:131], v[152:155], v[32:35]
    ds_read_b128 v[168:171], v2 offset:36864
    v_mfma_f32_16x16x32_bf16 v[80:83], v[140:143], v[152:155], v[80:83]
    ds_read_b64_tr_b16 v[192:193], v4 offset:24576
    v_mfma_f32_16x16x32_bf16 v[36:39], v[128:131], v[156:159], v[36:39]
    ds_read_b64_tr_b16 v[194:195], v4 offset:25600
    v_mfma_f32_16x16x32_bf16 v[84:87], v[140:143], v[156:159], v[84:87]
    ds_read_b128 v[180:183], v2 offset:39936
    v_mfma_f32_16x16x32_bf16 v[40:43], v[128:131], v[160:163], v[40:43]
    ds_read_b64_tr_b16 v[196:197], v5 offset:24576
    v_mfma_f32_16x16x32_bf16 v[88:91], v[140:143], v[160:163], v[88:91]
    ds_read_b64_tr_b16 v[198:199], v5 offset:25600
    v_mfma_f32_16x16x32_bf16 v[44:47], v[128:131], v[164:167], v[44:47]
    ds_read_b64_tr_b16 v[200:201], v6 offset:24576
    v_mfma_f32_16x16x32_bf16 v[92:95], v[140:143], v[164:167], v[92:95]
    ds_read_b64_tr_b16 v[202:203], v6 offset:25600
    v_mfma_f32_16x16x32_bf16 v[48:51], v[132:135], v[152:155], v[48:51]
    ds_read_b64_tr_b16 v[204:205], v7 offset:24576
    v_mfma_f32_16x16x32_bf16 v[96:99], v[144:147], v[152:155], v[96:99]
    ds_read_b64_tr_b16 v[206:207], v7 offset:25600
    v_mfma_f32_16x16x32_bf16 v[52:55], v[132:135], v[156:159], v[52:55]
    ds_read_b128 v[172:175], v2 offset:37888
    v_mfma_f32_16x16x32_bf16 v[100:103], v[144:147], v[156:159], v[100:103]
    ds_read_b128 v[184:187], v2 offset:40960
    v_mfma_f32_16x16x32_bf16 v[56:59], v[132:135], v[160:163], v[56:59]
    ds_read_b128 v[176:179], v2 offset:38912
    v_mfma_f32_16x16x32_bf16 v[104:107], v[144:147], v[160:163], v[104:107]
    ds_read_b128 v[188:191], v2 offset:41984
    v_mfma_f32_16x16x32_bf16 v[60:63], v[132:135], v[164:167], v[60:63]
    v_mfma_f32_16x16x32_bf16 v[108:111], v[144:147], v[164:167], v[108:111]
    v_mfma_f32_16x16x32_bf16 v[64:67], v[136:139], v[152:155], v[64:67]
    v_mfma_f32_16x16x32_bf16 v[112:115], v[148:151], v[152:155], v[112:115]
    v_mfma_f32_16x16x32_bf16 v[68:71], v[136:139], v[156:159], v[68:71]
    v_mfma_f32_16x16x32_bf16 v[116:119], v[148:151], v[156:159], v[116:119]
    v_mfma_f32_16x16x32_bf16 v[72:75], v[136:139], v[160:163], v[72:75]
    v_mfma_f32_16x16x32_bf16 v[120:123], v[148:151], v[160:163], v[120:123]
    v_mfma_f32_16x16x32_bf16 v[76:79], v[136:139], v[164:167], v[76:79]
    v_mfma_f32_16x16x32_bf16 v[124:127], v[148:151], v[164:167], v[124:127]
    s_waitcnt lgkmcnt(0)
    s_barrier
    v_mfma_f32_16x16x32_bf16 v[32:35], v[168:171], v[192:195], v[32:35]
    ds_read_b128 v[128:131], v2 offset:49152
    v_mfma_f32_16x16x32_bf16 v[80:83], v[180:183], v[192:195], v[80:83]
    ds_read_b64_tr_b16 v[152:153], v4 offset:32768
    v_mfma_f32_16x16x32_bf16 v[36:39], v[168:171], v[196:199], v[36:39]
    ds_read_b64_tr_b16 v[154:155], v4 offset:33792
    v_mfma_f32_16x16x32_bf16 v[84:87], v[180:183], v[196:199], v[84:87]
    ds_read_b128 v[140:143], v2 offset:52224
    v_mfma_f32_16x16x32_bf16 v[40:43], v[168:171], v[200:203], v[40:43]
    ds_read_b64_tr_b16 v[156:157], v5 offset:32768
    v_mfma_f32_16x16x32_bf16 v[88:91], v[180:183], v[200:203], v[88:91]
    ds_read_b64_tr_b16 v[158:159], v5 offset:33792
    v_mfma_f32_16x16x32_bf16 v[44:47], v[168:171], v[204:207], v[44:47]
    ds_read_b64_tr_b16 v[160:161], v6 offset:32768
    v_mfma_f32_16x16x32_bf16 v[92:95], v[180:183], v[204:207], v[92:95]
    ds_read_b64_tr_b16 v[162:163], v6 offset:33792
    v_mfma_f32_16x16x32_bf16 v[48:51], v[172:175], v[192:195], v[48:51]
    ds_read_b64_tr_b16 v[164:165], v7 offset:32768
    v_mfma_f32_16x16x32_bf16 v[96:99], v[184:187], v[192:195], v[96:99]
    ds_read_b64_tr_b16 v[166:167], v7 offset:33792
    v_mfma_f32_16x16x32_bf16 v[52:55], v[172:175], v[196:199], v[52:55]
    ds_read_b128 v[132:135], v2 offset:50176
    v_mfma_f32_16x16x32_bf16 v[100:103], v[184:187], v[196:199], v[100:103]
    ds_read_b128 v[144:147], v2 offset:53248
    v_mfma_f32_16x16x32_bf16 v[56:59], v[172:175], v[200:203], v[56:59]
    ds_read_b128 v[136:139], v2 offset:51200
    v_mfma_f32_16x16x32_bf16 v[104:107], v[184:187], v[200:203], v[104:107]
    ds_read_b128 v[148:151], v2 offset:54272
    v_mfma_f32_16x16x32_bf16 v[60:63], v[172:175], v[204:207], v[60:63]
    v_mfma_f32_16x16x32_bf16 v[108:111], v[184:187], v[204:207], v[108:111]
    v_mfma_f32_16x16x32_bf16 v[64:67], v[176:179], v[192:195], v[64:67]
    v_mfma_f32_16x16x32_bf16 v[112:115], v[188:191], v[192:195], v[112:115]
    v_mfma_f32_16x16x32_bf16 v[68:71], v[176:179], v[196:199], v[68:71]
    v_mfma_f32_16x16x32_bf16 v[116:119], v[188:191], v[196:199], v[116:119]
    v_mfma_f32_16x16x32_bf16 v[72:75], v[176:179], v[200:203], v[72:75]
    v_mfma_f32_16x16x32_bf16 v[120:123], v[188:191], v[200:203], v[120:123]
    v_mfma_f32_16x16x32_bf16 v[76:79], v[176:179], v[204:207], v[76:79]
    v_mfma_f32_16x16x32_bf16 v[124:127], v[188:191], v[204:207], v[124:127]
    s_waitcnt lgkmcnt(0)
    s_barrier
    v_mfma_f32_16x16x32_bf16 v[32:35], v[128:131], v[152:155], v[32:35]
    ds_read_b128 v[168:171], v3 offset:0
    v_mfma_f32_16x16x32_bf16 v[80:83], v[140:143], v[152:155], v[80:83]
    ds_read_b64_tr_b16 v[192:193], v4 offset:40960
    v_mfma_f32_16x16x32_bf16 v[36:39], v[128:131], v[156:159], v[36:39]
    ds_read_b64_tr_b16 v[194:195], v4 offset:41984
    v_mfma_f32_16x16x32_bf16 v[84:87], v[140:143], v[156:159], v[84:87]
    ds_read_b128 v[180:183], v3 offset:3072
    v_mfma_f32_16x16x32_bf16 v[40:43], v[128:131], v[160:163], v[40:43]
    ds_read_b64_tr_b16 v[196:197], v5 offset:40960
    v_mfma_f32_16x16x32_bf16 v[88:91], v[140:143], v[160:163], v[88:91]
    ds_read_b64_tr_b16 v[198:199], v5 offset:41984
    v_mfma_f32_16x16x32_bf16 v[44:47], v[128:131], v[164:167], v[44:47]
    ds_read_b64_tr_b16 v[200:201], v6 offset:40960
    v_mfma_f32_16x16x32_bf16 v[92:95], v[140:143], v[164:167], v[92:95]
    ds_read_b64_tr_b16 v[202:203], v6 offset:41984
    v_mfma_f32_16x16x32_bf16 v[48:51], v[132:135], v[152:155], v[48:51]
    ds_read_b64_tr_b16 v[204:205], v7 offset:40960
    v_mfma_f32_16x16x32_bf16 v[96:99], v[144:147], v[152:155], v[96:99]
    ds_read_b64_tr_b16 v[206:207], v7 offset:41984
    v_mfma_f32_16x16x32_bf16 v[52:55], v[132:135], v[156:159], v[52:55]
    ds_read_b128 v[172:175], v3 offset:1024
    v_mfma_f32_16x16x32_bf16 v[100:103], v[144:147], v[156:159], v[100:103]
    ds_read_b128 v[184:187], v3 offset:4096
    v_mfma_f32_16x16x32_bf16 v[56:59], v[132:135], v[160:163], v[56:59]
    ds_read_b128 v[176:179], v3 offset:2048
    v_mfma_f32_16x16x32_bf16 v[104:107], v[144:147], v[160:163], v[104:107]
    ds_read_b128 v[188:191], v3 offset:5120
    v_mfma_f32_16x16x32_bf16 v[60:63], v[132:135], v[164:167], v[60:63]
    v_mfma_f32_16x16x32_bf16 v[108:111], v[144:147], v[164:167], v[108:111]
    v_mfma_f32_16x16x32_bf16 v[64:67], v[136:139], v[152:155], v[64:67]
    v_mfma_f32_16x16x32_bf16 v[112:115], v[148:151], v[152:155], v[112:115]
    v_mfma_f32_16x16x32_bf16 v[68:71], v[136:139], v[156:159], v[68:71]
    v_mfma_f32_16x16x32_bf16 v[116:119], v[148:151], v[156:159], v[116:119]
    v_mfma_f32_16x16x32_bf16 v[72:75], v[136:139], v[160:163], v[72:75]
    v_mfma_f32_16x16x32_bf16 v[120:123], v[148:151], v[160:163], v[120:123]
    v_mfma_f32_16x16x32_bf16 v[76:79], v[136:139], v[164:167], v[76:79]
    v_mfma_f32_16x16x32_bf16 v[124:127], v[148:151], v[164:167], v[124:127]
    s_waitcnt lgkmcnt(0)
    s_barrier
    v_mfma_f32_16x16x32_bf16 v[32:35], v[168:171], v[192:195], v[32:35]
    ds_read_b128 v[208:211], v12 offset:0
    v_mfma_f32_16x16x32_bf16 v[80:83], v[180:183], v[192:195], v[80:83]
    ds_read_b128 v[212:215], v12 offset:256
    v_mfma_f32_16x16x32_bf16 v[36:39], v[168:171], v[196:199], v[36:39]
    ds_read_b128 v[216:219], v12 offset:512
    v_mfma_f32_16x16x32_bf16 v[84:87], v[180:183], v[196:199], v[84:87]
    ds_read_b128 v[220:223], v12 offset:768
    v_mfma_f32_16x16x32_bf16 v[40:43], v[168:171], v[200:203], v[40:43]
    ds_read_b128 v[224:227], v13 offset:0
    v_mfma_f32_16x16x32_bf16 v[88:91], v[180:183], v[200:203], v[88:91]
    ds_read_b128 v[228:231], v13 offset:64
    v_mfma_f32_16x16x32_bf16 v[44:47], v[168:171], v[204:207], v[44:47]
    ds_read_b128 v[232:235], v13 offset:128
    v_mfma_f32_16x16x32_bf16 v[92:95], v[180:183], v[204:207], v[92:95]
    ds_read_b128 v[236:239], v13 offset:192
    v_mfma_f32_16x16x32_bf16 v[48:51], v[172:175], v[192:195], v[48:51]
    ds_read_b128 v[240:243], v13 offset:256
    v_mfma_f32_16x16x32_bf16 v[96:99], v[184:187], v[192:195], v[96:99]
    ds_read_b128 v[244:247], v13 offset:320
    v_mfma_f32_16x16x32_bf16 v[52:55], v[172:175], v[196:199], v[52:55]
    v_mfma_f32_16x16x32_bf16 v[100:103], v[184:187], v[196:199], v[100:103]
    v_mfma_f32_16x16x32_bf16 v[56:59], v[172:175], v[200:203], v[56:59]
    v_mfma_f32_16x16x32_bf16 v[104:107], v[184:187], v[200:203], v[104:107]
    v_mfma_f32_16x16x32_bf16 v[60:63], v[172:175], v[204:207], v[60:63]
    v_mfma_f32_16x16x32_bf16 v[108:111], v[184:187], v[204:207], v[108:111]
    v_mfma_f32_16x16x32_bf16 v[64:67], v[176:179], v[192:195], v[64:67]
    v_mfma_f32_16x16x32_bf16 v[112:115], v[188:191], v[192:195], v[112:115]
    v_mfma_f32_16x16x32_bf16 v[68:71], v[176:179], v[196:199], v[68:71]
    v_mfma_f32_16x16x32_bf16 v[116:119], v[188:191], v[196:199], v[116:119]
    v_mfma_f32_16x16x32_bf16 v[72:75], v[176:179], v[200:203], v[72:75]
    v_mfma_f32_16x16x32_bf16 v[120:123], v[188:191], v[200:203], v[120:123]
    v_mfma_f32_16x16x32_bf16 v[76:79], v[176:179], v[204:207], v[76:79]
    v_mfma_f32_16x16x32_bf16 v[124:127], v[188:191], v[204:207], v[124:127]
    s_waitcnt lgkmcnt(0)
    v_pk_fma_f32 v[32:33], v[224:225], v[210:211], v[32:33] op_sel_hi:[1,0,1]
    v_pk_fma_f32 v[34:35], v[226:227], v[210:211], v[34:35] op_sel_hi:[1,0,1]
    v_pk_fma_f32 v[36:37], v[224:225], v[214:215], v[36:37] op_sel_hi:[1,0,1]
    v_pk_fma_f32 v[38:39], v[226:227], v[214:215], v[38:39] op_sel_hi:[1,0,1]
    v_pk_fma_f32 v[80:81], v[236:237], v[210:211], v[80:81] op_sel_hi:[1,0,1]
    v_pk_fma_f32 v[82:83], v[238:239], v[210:211], v[82:83] op_sel_hi:[1,0,1]
    v_pk_fma_f32 v[84:85], v[236:237], v[214:215], v[84:85] op_sel_hi:[1,0,1]
    v_pk_fma_f32 v[86:87], v[238:239], v[214:215], v[86:87] op_sel_hi:[1,0,1]
    v_pk_mul_f32 v[144:145], v[32:33], v[208:209] op_sel_hi:[1,0]
    v_pk_mul_f32 v[148:149], v[34:35], v[208:209] op_sel_hi:[1,0]
    v_pk_mul_f32 v[152:153], v[36:37], v[212:213] op_sel_hi:[1,0]
    v_pk_mul_f32 v[156:157], v[38:39], v[212:213] op_sel_hi:[1,0]
    v_exp_f32 v144, v144
    v_exp_f32 v148, v148
    v_exp_f32 v152, v152
    v_exp_f32 v156, v156
    v_exp_f32 v145, v145
    v_exp_f32 v149, v149
    v_exp_f32 v153, v153
    v_exp_f32 v157, v157
    v_pk_mul_f32 v[146:147], v[32:33], v[80:81]
    v_pk_mul_f32 v[150:151], v[34:35], v[82:83]
    v_pk_mul_f32 v[154:155], v[36:37], v[84:85]
    v_pk_mul_f32 v[158:159], v[38:39], v[86:87]
    v_pk_fma_f32 v[144:145], v[144:145], v[208:209], v[208:209] op_sel:[0,1,1] op_sel_hi:[1,1,1]
    v_pk_fma_f32 v[148:149], v[148:149], v[208:209], v[208:209] op_sel:[0,1,1] op_sel_hi:[1,1,1]
    v_pk_fma_f32 v[152:153], v[152:153], v[212:213], v[212:213] op_sel:[0,1,1] op_sel_hi:[1,1,1]
    v_pk_fma_f32 v[156:157], v[156:157], v[212:213], v[212:213] op_sel:[0,1,1] op_sel_hi:[1,1,1]
    v_rcp_f32 v144, v144
    v_rcp_f32 v148, v148
    v_rcp_f32 v152, v152
    v_rcp_f32 v156, v156
    v_rcp_f32 v145, v145
    v_rcp_f32 v149, v149
    v_rcp_f32 v153, v153
    v_rcp_f32 v157, v157
    v_pk_mul_f32 v[146:147], v[146:147], v[144:145]
    v_pk_mul_f32 v[150:151], v[150:151], v[148:149]
    v_pk_mul_f32 v[154:155], v[154:155], v[152:153]
    v_pk_mul_f32 v[158:159], v[158:159], v[156:157]
    v_cvt_pk_bf16_f32 v128, v146, v147
    v_cvt_pk_bf16_f32 v129, v150, v151
    v_cvt_pk_bf16_f32 v130, v154, v155
    v_cvt_pk_bf16_f32 v131, v158, v159
    s_nop 0
    v_permlane16_swap_b32 v128, v130
    v_permlane16_swap_b32 v129, v131
    buffer_store_dwordx4 v[128:131], v14, s[8:11], s28 offen offset:0 sc1
    v_pk_fma_f32 v[40:41], v[224:225], v[218:219], v[40:41] op_sel_hi:[1,0,1]
    v_pk_fma_f32 v[42:43], v[226:227], v[218:219], v[42:43] op_sel_hi:[1,0,1]
    v_pk_fma_f32 v[44:45], v[224:225], v[222:223], v[44:45] op_sel_hi:[1,0,1]
    v_pk_fma_f32 v[46:47], v[226:227], v[222:223], v[46:47] op_sel_hi:[1,0,1]
    v_pk_fma_f32 v[88:89], v[236:237], v[218:219], v[88:89] op_sel_hi:[1,0,1]
    v_pk_fma_f32 v[90:91], v[238:239], v[218:219], v[90:91] op_sel_hi:[1,0,1]
    v_pk_fma_f32 v[92:93], v[236:237], v[222:223], v[92:93] op_sel_hi:[1,0,1]
    v_pk_fma_f32 v[94:95], v[238:239], v[222:223], v[94:95] op_sel_hi:[1,0,1]
    v_pk_mul_f32 v[144:145], v[40:41], v[216:217] op_sel_hi:[1,0]
    v_pk_mul_f32 v[148:149], v[42:43], v[216:217] op_sel_hi:[1,0]
    v_pk_mul_f32 v[152:153], v[44:45], v[220:221] op_sel_hi:[1,0]
    v_pk_mul_f32 v[156:157], v[46:47], v[220:221] op_sel_hi:[1,0]
    v_exp_f32 v144, v144
    v_exp_f32 v148, v148
    v_exp_f32 v152, v152
    v_exp_f32 v156, v156
    v_exp_f32 v145, v145
    v_exp_f32 v149, v149
    v_exp_f32 v153, v153
    v_exp_f32 v157, v157
    v_pk_mul_f32 v[146:147], v[40:41], v[88:89]
    v_pk_mul_f32 v[150:151], v[42:43], v[90:91]
    v_pk_mul_f32 v[154:155], v[44:45], v[92:93]
    v_pk_mul_f32 v[158:159], v[46:47], v[94:95]
    v_pk_fma_f32 v[144:145], v[144:145], v[216:217], v[216:217] op_sel:[0,1,1] op_sel_hi:[1,1,1]
    v_pk_fma_f32 v[148:149], v[148:149], v[216:217], v[216:217] op_sel:[0,1,1] op_sel_hi:[1,1,1]
    v_pk_fma_f32 v[152:153], v[152:153], v[220:221], v[220:221] op_sel:[0,1,1] op_sel_hi:[1,1,1]
    v_pk_fma_f32 v[156:157], v[156:157], v[220:221], v[220:221] op_sel:[0,1,1] op_sel_hi:[1,1,1]
    v_rcp_f32 v144, v144
    v_rcp_f32 v148, v148
    v_rcp_f32 v152, v152
    v_rcp_f32 v156, v156
    v_rcp_f32 v145, v145
    v_rcp_f32 v149, v149
    v_rcp_f32 v153, v153
    v_rcp_f32 v157, v157
    v_pk_mul_f32 v[146:147], v[146:147], v[144:145]
    v_pk_mul_f32 v[150:151], v[150:151], v[148:149]
    v_pk_mul_f32 v[154:155], v[154:155], v[152:153]
    v_pk_mul_f32 v[158:159], v[158:159], v[156:157]
    v_cvt_pk_bf16_f32 v132, v146, v147
    v_cvt_pk_bf16_f32 v133, v150, v151
    v_cvt_pk_bf16_f32 v134, v154, v155
    v_cvt_pk_bf16_f32 v135, v158, v159
    s_nop 0
    v_permlane16_swap_b32 v132, v134
    v_permlane16_swap_b32 v133, v135
    buffer_store_dwordx4 v[132:135], v14, s[8:11], s29 offen offset:0 sc1
    v_pk_fma_f32 v[48:49], v[228:229], v[210:211], v[48:49] op_sel_hi:[1,0,1]
    v_pk_fma_f32 v[50:51], v[230:231], v[210:211], v[50:51] op_sel_hi:[1,0,1]
    v_pk_fma_f32 v[52:53], v[228:229], v[214:215], v[52:53] op_sel_hi:[1,0,1]
    v_pk_fma_f32 v[54:55], v[230:231], v[214:215], v[54:55] op_sel_hi:[1,0,1]
    v_pk_fma_f32 v[96:97], v[240:241], v[210:211], v[96:97] op_sel_hi:[1,0,1]
    v_pk_fma_f32 v[98:99], v[242:243], v[210:211], v[98:99] op_sel_hi:[1,0,1]
    v_pk_fma_f32 v[100:101], v[240:241], v[214:215], v[100:101] op_sel_hi:[1,0,1]
    v_pk_fma_f32 v[102:103], v[242:243], v[214:215], v[102:103] op_sel_hi:[1,0,1]
    v_pk_mul_f32 v[144:145], v[48:49], v[208:209] op_sel_hi:[1,0]
    v_pk_mul_f32 v[148:149], v[50:51], v[208:209] op_sel_hi:[1,0]
    v_pk_mul_f32 v[152:153], v[52:53], v[212:213] op_sel_hi:[1,0]
    v_pk_mul_f32 v[156:157], v[54:55], v[212:213] op_sel_hi:[1,0]
    v_exp_f32 v144, v144
    v_exp_f32 v148, v148
    v_exp_f32 v152, v152
    v_exp_f32 v156, v156
    v_exp_f32 v145, v145
    v_exp_f32 v149, v149
    v_exp_f32 v153, v153
    v_exp_f32 v157, v157
    v_pk_mul_f32 v[146:147], v[48:49], v[96:97]
    v_pk_mul_f32 v[150:151], v[50:51], v[98:99]
    v_pk_mul_f32 v[154:155], v[52:53], v[100:101]
    v_pk_mul_f32 v[158:159], v[54:55], v[102:103]
    v_pk_fma_f32 v[144:145], v[144:145], v[208:209], v[208:209] op_sel:[0,1,1] op_sel_hi:[1,1,1]
    v_pk_fma_f32 v[148:149], v[148:149], v[208:209], v[208:209] op_sel:[0,1,1] op_sel_hi:[1,1,1]
    v_pk_fma_f32 v[152:153], v[152:153], v[212:213], v[212:213] op_sel:[0,1,1] op_sel_hi:[1,1,1]
    v_pk_fma_f32 v[156:157], v[156:157], v[212:213], v[212:213] op_sel:[0,1,1] op_sel_hi:[1,1,1]
    v_rcp_f32 v144, v144
    v_rcp_f32 v148, v148
    v_rcp_f32 v152, v152
    v_rcp_f32 v156, v156
    v_rcp_f32 v145, v145
    v_rcp_f32 v149, v149
    v_rcp_f32 v153, v153
    v_rcp_f32 v157, v157
    v_pk_mul_f32 v[146:147], v[146:147], v[144:145]
    v_pk_mul_f32 v[150:151], v[150:151], v[148:149]
    v_pk_mul_f32 v[154:155], v[154:155], v[152:153]
    v_pk_mul_f32 v[158:159], v[158:159], v[156:157]
    v_cvt_pk_bf16_f32 v136, v146, v147
    v_cvt_pk_bf16_f32 v137, v150, v151
    v_cvt_pk_bf16_f32 v138, v154, v155
    v_cvt_pk_bf16_f32 v139, v158, v159
    s_nop 0
    v_permlane16_swap_b32 v136, v138
    v_permlane16_swap_b32 v137, v139
    buffer_store_dwordx4 v[136:139], v14, s[8:11], s28 offen offset:512 sc1
    v_pk_fma_f32 v[56:57], v[228:229], v[218:219], v[56:57] op_sel_hi:[1,0,1]
    v_pk_fma_f32 v[58:59], v[230:231], v[218:219], v[58:59] op_sel_hi:[1,0,1]
    v_pk_fma_f32 v[60:61], v[228:229], v[222:223], v[60:61] op_sel_hi:[1,0,1]
    v_pk_fma_f32 v[62:63], v[230:231], v[222:223], v[62:63] op_sel_hi:[1,0,1]
    v_pk_fma_f32 v[104:105], v[240:241], v[218:219], v[104:105] op_sel_hi:[1,0,1]
    v_pk_fma_f32 v[106:107], v[242:243], v[218:219], v[106:107] op_sel_hi:[1,0,1]
    v_pk_fma_f32 v[108:109], v[240:241], v[222:223], v[108:109] op_sel_hi:[1,0,1]
    v_pk_fma_f32 v[110:111], v[242:243], v[222:223], v[110:111] op_sel_hi:[1,0,1]
    v_pk_mul_f32 v[144:145], v[56:57], v[216:217] op_sel_hi:[1,0]
    v_pk_mul_f32 v[148:149], v[58:59], v[216:217] op_sel_hi:[1,0]
    v_pk_mul_f32 v[152:153], v[60:61], v[220:221] op_sel_hi:[1,0]
    v_pk_mul_f32 v[156:157], v[62:63], v[220:221] op_sel_hi:[1,0]
    v_exp_f32 v144, v144
    v_exp_f32 v148, v148
    v_exp_f32 v152, v152
    v_exp_f32 v156, v156
    v_exp_f32 v145, v145
    v_exp_f32 v149, v149
    v_exp_f32 v153, v153
    v_exp_f32 v157, v157
    v_pk_mul_f32 v[146:147], v[56:57], v[104:105]
    v_pk_mul_f32 v[150:151], v[58:59], v[106:107]
    v_pk_mul_f32 v[154:155], v[60:61], v[108:109]
    v_pk_mul_f32 v[158:159], v[62:63], v[110:111]
    v_pk_fma_f32 v[144:145], v[144:145], v[216:217], v[216:217] op_sel:[0,1,1] op_sel_hi:[1,1,1]
    v_pk_fma_f32 v[148:149], v[148:149], v[216:217], v[216:217] op_sel:[0,1,1] op_sel_hi:[1,1,1]
    v_pk_fma_f32 v[152:153], v[152:153], v[220:221], v[220:221] op_sel:[0,1,1] op_sel_hi:[1,1,1]
    v_pk_fma_f32 v[156:157], v[156:157], v[220:221], v[220:221] op_sel:[0,1,1] op_sel_hi:[1,1,1]
    v_rcp_f32 v144, v144
    v_rcp_f32 v148, v148
    v_rcp_f32 v152, v152
    v_rcp_f32 v156, v156
    v_rcp_f32 v145, v145
    v_rcp_f32 v149, v149
    v_rcp_f32 v153, v153
    v_rcp_f32 v157, v157
    v_pk_mul_f32 v[146:147], v[146:147], v[144:145]
    v_pk_mul_f32 v[150:151], v[150:151], v[148:149]
    v_pk_mul_f32 v[154:155], v[154:155], v[152:153]
    v_pk_mul_f32 v[158:159], v[158:159], v[156:157]
    v_cvt_pk_bf16_f32 v140, v146, v147
    v_cvt_pk_bf16_f32 v141, v150, v151
    v_cvt_pk_bf16_f32 v142, v154, v155
    v_cvt_pk_bf16_f32 v143, v158, v159
    s_nop 0
    v_permlane16_swap_b32 v140, v142
    v_permlane16_swap_b32 v141, v143
    buffer_store_dwordx4 v[140:143], v14, s[8:11], s29 offen offset:512 sc1
    v_pk_fma_f32 v[64:65], v[232:233], v[210:211], v[64:65] op_sel_hi:[1,0,1]
    v_pk_fma_f32 v[66:67], v[234:235], v[210:211], v[66:67] op_sel_hi:[1,0,1]
    v_pk_fma_f32 v[68:69], v[232:233], v[214:215], v[68:69] op_sel_hi:[1,0,1]
    v_pk_fma_f32 v[70:71], v[234:235], v[214:215], v[70:71] op_sel_hi:[1,0,1]
    v_pk_fma_f32 v[112:113], v[244:245], v[210:211], v[112:113] op_sel_hi:[1,0,1]
    v_pk_fma_f32 v[114:115], v[246:247], v[210:211], v[114:115] op_sel_hi:[1,0,1]
    v_pk_fma_f32 v[116:117], v[244:245], v[214:215], v[116:117] op_sel_hi:[1,0,1]
    v_pk_fma_f32 v[118:119], v[246:247], v[214:215], v[118:119] op_sel_hi:[1,0,1]
    v_pk_mul_f32 v[144:145], v[64:65], v[208:209] op_sel_hi:[1,0]
    v_pk_mul_f32 v[148:149], v[66:67], v[208:209] op_sel_hi:[1,0]
    v_pk_mul_f32 v[152:153], v[68:69], v[212:213] op_sel_hi:[1,0]
    v_pk_mul_f32 v[156:157], v[70:71], v[212:213] op_sel_hi:[1,0]
    v_exp_f32 v144, v144
    v_exp_f32 v148, v148
    v_exp_f32 v152, v152
    v_exp_f32 v156, v156
    v_exp_f32 v145, v145
    v_exp_f32 v149, v149
    v_exp_f32 v153, v153
    v_exp_f32 v157, v157
    v_pk_mul_f32 v[146:147], v[64:65], v[112:113]
    v_pk_mul_f32 v[150:151], v[66:67], v[114:115]
    v_pk_mul_f32 v[154:155], v[68:69], v[116:117]
    v_pk_mul_f32 v[158:159], v[70:71], v[118:119]
    v_pk_fma_f32 v[144:145], v[144:145], v[208:209], v[208:209] op_sel:[0,1,1] op_sel_hi:[1,1,1]
    v_pk_fma_f32 v[148:149], v[148:149], v[208:209], v[208:209] op_sel:[0,1,1] op_sel_hi:[1,1,1]
    v_pk_fma_f32 v[152:153], v[152:153], v[212:213], v[212:213] op_sel:[0,1,1] op_sel_hi:[1,1,1]
    v_pk_fma_f32 v[156:157], v[156:157], v[212:213], v[212:213] op_sel:[0,1,1] op_sel_hi:[1,1,1]
    v_rcp_f32 v144, v144
    v_rcp_f32 v148, v148
    v_rcp_f32 v152, v152
    v_rcp_f32 v156, v156
    v_rcp_f32 v145, v145
    v_rcp_f32 v149, v149
    v_rcp_f32 v153, v153
    v_rcp_f32 v157, v157
    v_pk_mul_f32 v[146:147], v[146:147], v[144:145]
    v_pk_mul_f32 v[150:151], v[150:151], v[148:149]
    v_pk_mul_f32 v[154:155], v[154:155], v[152:153]
    v_pk_mul_f32 v[158:159], v[158:159], v[156:157]
    v_cvt_pk_bf16_f32 v128, v146, v147
    v_cvt_pk_bf16_f32 v129, v150, v151
    v_cvt_pk_bf16_f32 v130, v154, v155
    v_cvt_pk_bf16_f32 v131, v158, v159
    s_nop 0
    v_permlane16_swap_b32 v128, v130
    v_permlane16_swap_b32 v129, v131
    buffer_store_dwordx4 v[128:131], v14, s[8:11], s28 offen offset:1024 sc1
    v_pk_fma_f32 v[72:73], v[232:233], v[218:219], v[72:73] op_sel_hi:[1,0,1]
    v_pk_fma_f32 v[74:75], v[234:235], v[218:219], v[74:75] op_sel_hi:[1,0,1]
    v_pk_fma_f32 v[76:77], v[232:233], v[222:223], v[76:77] op_sel_hi:[1,0,1]
    v_pk_fma_f32 v[78:79], v[234:235], v[222:223], v[78:79] op_sel_hi:[1,0,1]
    v_pk_fma_f32 v[120:121], v[244:245], v[218:219], v[120:121] op_sel_hi:[1,0,1]
    v_pk_fma_f32 v[122:123], v[246:247], v[218:219], v[122:123] op_sel_hi:[1,0,1]
    v_pk_fma_f32 v[124:125], v[244:245], v[222:223], v[124:125] op_sel_hi:[1,0,1]
    v_pk_fma_f32 v[126:127], v[246:247], v[222:223], v[126:127] op_sel_hi:[1,0,1]
    v_pk_mul_f32 v[144:145], v[72:73], v[216:217] op_sel_hi:[1,0]
    v_pk_mul_f32 v[148:149], v[74:75], v[216:217] op_sel_hi:[1,0]
    v_pk_mul_f32 v[152:153], v[76:77], v[220:221] op_sel_hi:[1,0]
    v_pk_mul_f32 v[156:157], v[78:79], v[220:221] op_sel_hi:[1,0]
    v_exp_f32 v144, v144
    v_exp_f32 v148, v148
    v_exp_f32 v152, v152
    v_exp_f32 v156, v156
    v_exp_f32 v145, v145
    v_exp_f32 v149, v149
    v_exp_f32 v153, v153
    v_exp_f32 v157, v157
    v_pk_mul_f32 v[146:147], v[72:73], v[120:121]
    v_pk_mul_f32 v[150:151], v[74:75], v[122:123]
    v_pk_mul_f32 v[154:155], v[76:77], v[124:125]
    v_pk_mul_f32 v[158:159], v[78:79], v[126:127]
    v_pk_fma_f32 v[144:145], v[144:145], v[216:217], v[216:217] op_sel:[0,1,1] op_sel_hi:[1,1,1]
    v_pk_fma_f32 v[148:149], v[148:149], v[216:217], v[216:217] op_sel:[0,1,1] op_sel_hi:[1,1,1]
    v_pk_fma_f32 v[152:153], v[152:153], v[220:221], v[220:221] op_sel:[0,1,1] op_sel_hi:[1,1,1]
    v_pk_fma_f32 v[156:157], v[156:157], v[220:221], v[220:221] op_sel:[0,1,1] op_sel_hi:[1,1,1]
    v_rcp_f32 v144, v144
    v_rcp_f32 v148, v148
    v_rcp_f32 v152, v152
    v_rcp_f32 v156, v156
    v_rcp_f32 v145, v145
    v_rcp_f32 v149, v149
    v_rcp_f32 v153, v153
    v_rcp_f32 v157, v157
    v_pk_mul_f32 v[146:147], v[146:147], v[144:145]
    v_pk_mul_f32 v[150:151], v[150:151], v[148:149]
    v_pk_mul_f32 v[154:155], v[154:155], v[152:153]
    v_pk_mul_f32 v[158:159], v[158:159], v[156:157]
    v_cvt_pk_bf16_f32 v132, v146, v147
    v_cvt_pk_bf16_f32 v133, v150, v151
    v_cvt_pk_bf16_f32 v134, v154, v155
    v_cvt_pk_bf16_f32 v135, v158, v159
    s_nop 0
    v_permlane16_swap_b32 v132, v134
    v_permlane16_swap_b32 v133, v135
    buffer_store_dwordx4 v[132:135], v14, s[8:11], s29 offen offset:1024 sc1
    v_lshlrev_b32 v2, 4, v1
    s_lshl_b32 s26, s98, 2
    s_and_b32 s30, s20, 1
    s_lshl_b32 s32, s30, 10
    s_add_u32 s32, s32, 15204352
    s_add_u32 s27, s26, s20
    s_mul_i32 s27, s27, 49152
    s_add_u32 s27, s27, s32
    s_xor_b32 s31, s20, 1
    s_add_u32 s31, s31, s26
    s_mul_i32 s31, s31, 49152
    s_add_u32 s31, s31, s32
    s_add_u32 s26, s26, s20
    v_lshrrev_b32 v6, 4, v1
    v_bfe_u32 v7, v1, 2, 2
    v_lshl_add_u32 v7, v6, 2, v7
    v_lshlrev_b32 v7, 7, v7
    v_and_b32 v8, 3, v1
    v_lshl_add_u32 v7, v8, 3, v7
    s_lshl_b32 s28, s20, 5
    s_add_u32 s28, s28, 143360
    v_add_u32 v7, s28, v7
    v_and_b32 v8, 15, v1
    v_mul_u32_u24 v8, 1280, v8
    s_mul_i32 s28, s26, 20480
    s_mul_i32 s29, s99, 160
    s_add_u32 s28, s28, s29
    v_lshl_add_u32 v9, v6, 3, v8
    v_and_b32 v10, 1, v6
    v_lshl_add_u32 v8, v10, 5, v8
    v_lshrrev_b32 v10, 1, v6
    v_lshl_add_u32 v8, v10, 4, v8
    s_mul_i32 s32, s30, 10240
    s_mul_i32 s33, s30, 83968
    s_mul_i32 s34, s30, -4096
    s_add_u32 s34, s34, 12288
    v_add_u32 v3, s32, v2
    v_add_u32 v4, s33, v2
    s_mul_i32 s32, s20, 5120
    s_add_u32 s32, s32, 118784
    v_add_u32 v11, s32, v2
    s_xor_b32 s32, s20, 1
    s_mul_i32 s32, s32, 5120
    s_add_u32 s32, s32, 118784
    v_add_u32 v12, s32, v2
    v_add_u32 v160, 0, v3
    s_mul_i32 s32, s34, 0
    v_add_u32 v161, s32, v4
    v_add_u32 v162, 12288, v3
    s_mul_i32 s32, s34, 1
    v_add_u32 v163, s32, v4
    v_add_u32 v164, 24576, v3
    s_mul_i32 s32, s34, 2
    v_add_u32 v165, s32, v4
    v_add_u32 v166, 36864, v3
    s_mul_i32 s32, s34, 3
    v_add_u32 v167, s32, v4
    v_add_u32 v168, 49152, v3
    s_mul_i32 s32, s34, 4
    v_add_u32 v169, s32, v4
    v_add_u32 v170, 61440, v3
    s_mul_i32 s32, s34, 5
    v_add_u32 v171, s32, v4
    v_add_u32 v172, 73728, v3
    s_mul_i32 s32, s34, 6
    v_add_u32 v173, s32, v4
    s_waitcnt vmcnt(0)
    s_barrier
    s_cmp_lg_u32 s20, 0
    s_cbranch_scc1 L_nosig_25
    v_mov_b32 v13, 0
    v_mov_b32 v14, s18
    s_mov_b64 exec, 1
    buffer_store_dword v14, v13, s[8:11], s36 offen sc1
    s_mov_b64 exec, -1
L_nosig_25:
    s_mov_b32 s12, s6
    s_and_b32 s13, s7, 0xffff
    s_mov_b32 s14, 2621440
    s_mov_b32 s15, 0x20000
    s_barrier
    buffer_load_dwordx4 v[96:99], v2, s[8:11], s27 offen offset:0 sc1
    buffer_load_dwordx4 v[100:103], v2, s[8:11], s31 offen offset:0 sc1
    buffer_load_dwordx4 v[104:107], v2, s[8:11], s27 offen offset:2048 sc1
    buffer_load_dwordx4 v[108:111], v2, s[8:11], s31 offen offset:2048 sc1
    s_add_u32 s27, s27, 4096
    s_add_u32 s31, s31, 4096
    buffer_load_dwordx4 v[112:115], v2, s[8:11], s27 offen offset:0 sc1
    buffer_load_dwordx4 v[116:119], v2, s[8:11], s31 offen offset:0 sc1
    buffer_load_dwordx4 v[120:123], v2, s[8:11], s27 offen offset:2048 sc1
    buffer_load_dwordx4 v[124:127], v2, s[8:11], s31 offen offset:2048 sc1
    s_add_u32 s27, s27, 4096
    s_add_u32 s31, s31, 4096
    buffer_load_dwordx4 v[128:131], v2, s[8:11], s27 offen offset:0 sc1
    buffer_load_dwordx4 v[132:135], v2, s[8:11], s31 offen offset:0 sc1
    ds_read_b128 v[56:59], v172 offset:0
    ds_read_b128 v[60:63], v172 offset:1024
    ds_read_b128 v[64:67], v173 offset:2048
    ds_read_b128 v[68:71], v173 offset:3072
    ds_read_b128 v[72:75], v173 offset:4096
    s_waitcnt vmcnt(8)
    s_waitcnt lgkmcnt(4)
    v_mfma_f32_16x16x32_bf16 v[16:19], v[56:59], v[96:99], 0
    ds_read_b128 v[76:79], v173 offset:5120
    v_mfma_f32_16x16x32_bf16 v[20:23], v[56:59], v[100:103], 0
    ds_read_b128 v[80:83], v173 offset:6144
    s_waitcnt lgkmcnt(5)
    v_mfma_f32_16x16x32_bf16 v[24:27], v[60:63], v[96:99], 0
    ds_read_b128 v[84:87], v173 offset:7168
    v_mfma_f32_16x16x32_bf16 v[28:31], v[60:63], v[100:103], 0
    ds_read_b128 v[88:91], v173 offset:8192
    s_waitcnt lgkmcnt(6)
    v_mfma_f32_16x16x32_bf16 v[32:35], v[64:67], v[96:99], 0
    ds_read_b128 v[92:95], v173 offset:9216
    v_mfma_f32_16x16x32_bf16 v[36:39], v[64:67], v[100:103], 0
    buffer_load_dwordx4 v[136:139], v2, s[8:11], s27 offen offset:2048 sc1
    s_waitcnt lgkmcnt(6)
    v_mfma_f32_16x16x32_bf16 v[40:43], v[68:71], v[96:99], 0
    v_mfma_f32_16x16x32_bf16 v[44:47], v[68:71], v[100:103], 0
    buffer_load_dwordx4 v[140:143], v2, s[8:11], s31 offen offset:2048 sc1
    s_add_u32 s27, s27, 4096
    s_add_u32 s31, s31, 4096
    s_waitcnt lgkmcnt(5)
    v_mfma_f32_16x16x32_bf16 v[48:51], v[72:75], v[96:99], 0
    v_mfma_f32_16x16x32_bf16 v[52:55], v[72:75], v[100:103], 0
    s_waitcnt lgkmcnt(0)
    s_barrier
    s_waitcnt vmcnt(8)
    v_mfma_f32_16x16x32_bf16 v[16:19], v[76:79], v[104:107], v[16:19]
    ds_read_b128 v[56:59], v160 offset:0
    v_mfma_f32_16x16x32_bf16 v[20:23], v[76:79], v[108:111], v[20:23]
    ds_read_b128 v[60:63], v160 offset:1024
    v_mfma_f32_16x16x32_bf16 v[24:27], v[80:83], v[104:107], v[24:27]
    ds_read_b128 v[64:67], v161 offset:2048
    v_mfma_f32_16x16x32_bf16 v[28:31], v[80:83], v[108:111], v[28:31]
    ds_read_b128 v[68:71], v161 offset:3072
    v_mfma_f32_16x16x32_bf16 v[32:35], v[84:87], v[104:107], v[32:35]
    ds_read_b128 v[72:75], v161 offset:4096
    v_mfma_f32_16x16x32_bf16 v[36:39], v[84:87], v[108:111], v[36:39]
    buffer_load_dwordx4 v[144:147], v2, s[8:11], s27 offen offset:0 sc1
    v_mfma_f32_16x16x32_bf16 v[40:43], v[88:91], v[104:107], v[40:43]
    v_mfma_f32_16x16x32_bf16 v[44:47], v[88:91], v[108:111], v[44:47]
    buffer_load_dwordx4 v[148:151], v2, s[8:11], s31 offen offset:0 sc1
    v_mfma_f32_16x16x32_bf16 v[48:51], v[92:95], v[104:107], v[48:51]
    v_mfma_f32_16x16x32_bf16 v[52:55], v[92:95], v[108:111], v[52:55]
    s_waitcnt vmcnt(8)
    s_waitcnt lgkmcnt(4)
    v_mfma_f32_16x16x32_bf16 v[16:19], v[56:59], v[112:115], v[16:19]
    ds_read_b128 v[76:79], v161 offset:5120
    v_mfma_f32_16x16x32_bf16 v[20:23], v[56:59], v[116:119], v[20:23]
    ds_read_b128 v[80:83], v161 offset:6144
    s_waitcnt lgkmcnt(5)
    v_mfma_f32_16x16x32_bf16 v[24:27], v[60:63], v[112:115], v[24:27]
    ds_read_b128 v[84:87], v161 offset:7168
    v_mfma_f32_16x16x32_bf16 v[28:31], v[60:63], v[116:119], v[28:31]
    ds_read_b128 v[88:91], v161 offset:8192
    s_waitcnt lgkmcnt(6)
    v_mfma_f32_16x16x32_bf16 v[32:35], v[64:67], v[112:115], v[32:35]
    ds_read_b128 v[92:95], v161 offset:9216
    v_mfma_f32_16x16x32_bf16 v[36:39], v[64:67], v[116:119], v[36:39]
    buffer_load_dwordx4 v[152:155], v2, s[8:11], s27 offen offset:2048 sc1
    s_waitcnt lgkmcnt(6)
    v_mfma_f32_16x16x32_bf16 v[40:43], v[68:71], v[112:115], v[40:43]
    v_mfma_f32_16x16x32_bf16 v[44:47], v[68:71], v[116:119], v[44:47]
    buffer_load_dwordx4 v[156:159], v2, s[8:11], s31 offen offset:2048 sc1
    s_add_u32 s27, s27, 4096
    s_add_u32 s31, s31, 4096
    s_waitcnt lgkmcnt(5)
    v_mfma_f32_16x16x32_bf16 v[48:51], v[72:75], v[112:115], v[48:51]
    v_mfma_f32_16x16x32_bf16 v[52:55], v[72:75], v[116:119], v[52:55]
    s_waitcnt lgkmcnt(0)
    s_barrier
    s_waitcnt vmcnt(8)
    v_mfma_f32_16x16x32_bf16 v[16:19], v[76:79], v[120:123], v[16:19]
    ds_read_b128 v[56:59], v162 offset:0
    v_mfma_f32_16x16x32_bf16 v[20:23], v[76:79], v[124:127], v[20:23]
    ds_read_b128 v[60:63], v162 offset:1024
    v_mfma_f32_16x16x32_bf16 v[24:27], v[80:83], v[120:123], v[24:27]
    ds_read_b128 v[64:67], v163 offset:2048
    v_mfma_f32_16x16x32_bf16 v[28:31], v[80:83], v[124:127], v[28:31]
    ds_read_b128 v[68:71], v163 offset:3072
    v_mfma_f32_16x16x32_bf16 v[32:35], v[84:87], v[120:123], v[32:35]
    ds_read_b128 v[72:75], v163 offset:4096
    v_mfma_f32_16x16x32_bf16 v[36:39], v[84:87], v[124:127], v[36:39]
    buffer_load_dwordx4 v[96:99], v2, s[8:11], s27 offen offset:0 sc1
    v_mfma_f32_16x16x32_bf16 v[40:43], v[88:91], v[120:123], v[40:43]
    v_mfma_f32_16x16x32_bf16 v[44:47], v[88:91], v[124:127], v[44:47]
    buffer_load_dwordx4 v[100:103], v2, s[8:11], s31 offen offset:0 sc1
    v_mfma_f32_16x16x32_bf16 v[48:51], v[92:95], v[120:123], v[48:51]
    v_mfma_f32_16x16x32_bf16 v[52:55], v[92:95], v[124:127], v[52:55]
    s_waitcnt vmcnt(8)
    s_waitcnt lgkmcnt(4)
    v_mfma_f32_16x16x32_bf16 v[16:19], v[56:59], v[128:131], v[16:19]
    ds_read_b128 v[76:79], v163 offset:5120
    v_mfma_f32_16x16x32_bf16 v[20:23], v[56:59], v[132:135], v[20:23]
    ds_read_b128 v[80:83], v163 offset:6144
    s_waitcnt lgkmcnt(5)
    v_mfma_f32_16x16x32_bf16 v[24:27], v[60:63], v[128:131], v[24:27]
    ds_read_b128 v[84:87], v163 offset:7168
    v_mfma_f32_16x16x32_bf16 v[28:31], v[60:63], v[132:135], v[28:31]
    ds_read_b128 v[88:91], v163 offset:8192
    s_waitcnt lgkmcnt(6)
    v_mfma_f32_16x16x32_bf16 v[32:35], v[64:67], v[128:131], v[32:35]
    ds_read_b128 v[92:95], v163 offset:9216
    v_mfma_f32_16x16x32_bf16 v[36:39], v[64:67], v[132:135], v[36:39]
    buffer_load_dwordx4 v[104:107], v2, s[8:11], s27 offen offset:2048 sc1
    s_waitcnt lgkmcnt(6)
    v_mfma_f32_16x16x32_bf16 v[40:43], v[68:71], v[128:131], v[40:43]
    v_mfma_f32_16x16x32_bf16 v[44:47], v[68:71], v[132:135], v[44:47]
    buffer_load_dwordx4 v[108:111], v2, s[8:11], s31 offen offset:2048 sc1
    s_add_u32 s27, s27, 4096
    s_add_u32 s31, s31, 4096
    s_waitcnt lgkmcnt(5)
    v_mfma_f32_16x16x32_bf16 v[48:51], v[72:75], v[128:131], v[48:51]
    v_mfma_f32_16x16x32_bf16 v[52:55], v[72:75], v[132:135], v[52:55]
    s_waitcnt lgkmcnt(0)
    s_barrier
    s_waitcnt vmcnt(8)
    v_mfma_f32_16x16x32_bf16 v[16:19], v[76:79], v[136:139], v[16:19]
    ds_read_b128 v[56:59], v164 offset:0
    v_mfma_f32_16x16x32_bf16 v[20:23], v[76:79], v[140:143], v[20:23]
    ds_read_b128 v[60:63], v164 offset:1024
    v_mfma_f32_16x16x32_bf16 v[24:27], v[80:83], v[136:139], v[24:27]
    ds_read_b128 v[64:67], v165 offset:2048
    v_mfma_f32_16x16x32_bf16 v[28:31], v[80:83], v[140:143], v[28:31]
    ds_read_b128 v[68:71], v165 offset:3072
    v_mfma_f32_16x16x32_bf16 v[32:35], v[84:87], v[136:139], v[32:35]
    ds_read_b128 v[72:75], v165 offset:4096
    v_mfma_f32_16x16x32_bf16 v[36:39], v[84:87], v[140:143], v[36:39]
    buffer_load_dwordx4 v[112:115], v2, s[8:11], s27 offen offset:0 sc1
    v_mfma_f32_16x16x32_bf16 v[40:43], v[88:91], v[136:139], v[40:43]
    v_mfma_f32_16x16x32_bf16 v[44:47], v[88:91], v[140:143], v[44:47]
    buffer_load_dwordx4 v[116:119], v2, s[8:11], s31 offen offset:0 sc1
    v_mfma_f32_16x16x32_bf16 v[48:51], v[92:95], v[136:139], v[48:51]
    v_mfma_f32_16x16x32_bf16 v[52:55], v[92:95], v[140:143], v[52:55]
    s_waitcnt vmcnt(8)
    s_waitcnt lgkmcnt(4)
    v_mfma_f32_16x16x32_bf16 v[16:19], v[56:59], v[144:147], v[16:19]
    ds_read_b128 v[76:79], v165 offset:5120
    v_mfma_f32_16x16x32_bf16 v[20:23], v[56:59], v[148:151], v[20:23]
    ds_read_b128 v[80:83], v165 offset:6144
    s_waitcnt lgkmcnt(5)
    v_mfma_f32_16x16x32_bf16 v[24:27], v[60:63], v[144:147], v[24:27]
    ds_read_b128 v[84:87], v165 offset:7168
    v_mfma_f32_16x16x32_bf16 v[28:31], v[60:63], v[148:151], v[28:31]
    ds_read_b128 v[88:91], v165 offset:8192
    s_waitcnt lgkmcnt(6)
    v_mfma_f32_16x16x32_bf16 v[32:35], v[64:67], v[144:147], v[32:35]
    ds_read_b128 v[92:95], v165 offset:9216
    v_mfma_f32_16x16x32_bf16 v[36:39], v[64:67], v[148:151], v[36:39]
    buffer_load_dwordx4 v[120:123], v2, s[8:11], s27 offen offset:2048 sc1
    s_waitcnt lgkmcnt(6)
    v_mfma_f32_16x16x32_bf16 v[40:43], v[68:71], v[144:147], v[40:43]
    v_mfma_f32_16x16x32_bf16 v[44:47], v[68:71], v[148:151], v[44:47]
    buffer_load_dwordx4 v[124:127], v2, s[8:11], s31 offen offset:2048 sc1
    s_add_u32 s27, s27, 4096
    s_add_u32 s31, s31, 4096
    s_waitcnt lgkmcnt(5)
    v_mfma_f32_16x16x32_bf16 v[48:51], v[72:75], v[144:147], v[48:51]
    v_mfma_f32_16x16x32_bf16 v[52:55], v[72:75], v[148:151], v[52:55]
    s_waitcnt lgkmcnt(0)
    s_barrier
    s_waitcnt vmcnt(8)
    v_mfma_f32_16x16x32_bf16 v[16:19], v[76:79], v[152:155], v[16:19]
    ds_read_b128 v[56:59], v166 offset:0
    v_mfma_f32_16x16x32_bf16 v[20:23], v[76:79], v[156:159], v[20:23]
    ds_read_b128 v[60:63], v166 offset:1024
    v_mfma_f32_16x16x32_bf16 v[24:27], v[80:83], v[152:155], v[24:27]
    ds_read_b128 v[64:67], v167 offset:2048
    v_mfma_f32_16x16x32_bf16 v[28:31], v[80:83], v[156:159], v[28:31]
    ds_read_b128 v[68:71], v167 offset:3072
    v_mfma_f32_16x16x32_bf16 v[32:35], v[84:87], v[152:155], v[32:35]
    ds_read_b128 v[72:75], v167 offset:4096
    v_mfma_f32_16x16x32_bf16 v[36:39], v[84:87], v[156:159], v[36:39]
    buffer_load_dwordx4 v[128:131], v2, s[8:11], s27 offen offset:0 sc1
    v_mfma_f32_16x16x32_bf16 v[40:43], v[88:91], v[152:155], v[40:43]
    v_mfma_f32_16x16x32_bf16 v[44:47], v[88:91], v[156:159], v[44:47]
    buffer_load_dwordx4 v[132:135], v2, s[8:11], s31 offen offset:0 sc1
    v_mfma_f32_16x16x32_bf16 v[48:51], v[92:95], v[152:155], v[48:51]
    v_mfma_f32_16x16x32_bf16 v[52:55], v[92:95], v[156:159], v[52:55]
    s_waitcnt vmcnt(8)
    s_waitcnt lgkmcnt(4)
    v_mfma_f32_16x16x32_bf16 v[16:19], v[56:59], v[96:99], v[16:19]
    ds_read_b128 v[76:79], v167 offset:5120
    v_mfma_f32_16x16x32_bf16 v[20:23], v[56:59], v[100:103], v[20:23]
    ds_read_b128 v[80:83], v167 offset:6144
    s_waitcnt lgkmcnt(5)
    v_mfma_f32_16x16x32_bf16 v[24:27], v[60:63], v[96:99], v[24:27]
    ds_read_b128 v[84:87], v167 offset:7168
    v_mfma_f32_16x16x32_bf16 v[28:31], v[60:63], v[100:103], v[28:31]
    ds_read_b128 v[88:91], v167 offset:8192
    s_waitcnt lgkmcnt(6)
    v_mfma_f32_16x16x32_bf16 v[32:35], v[64:67], v[96:99], v[32:35]
    ds_read_b128 v[92:95], v167 offset:9216
    v_mfma_f32_16x16x32_bf16 v[36:39], v[64:67], v[100:103], v[36:39]
    buffer_load_dwordx4 v[136:139], v2, s[8:11], s27 offen offset:2048 sc1
    s_waitcnt lgkmcnt(6)
    v_mfma_f32_16x16x32_bf16 v[40:43], v[68:71], v[96:99], v[40:43]
    v_mfma_f32_16x16x32_bf16 v[44:47], v[68:71], v[100:103], v[44:47]
    buffer_load_dwordx4 v[140:143], v2, s[8:11], s31 offen offset:2048 sc1
    s_add_u32 s27, s27, 4096
    s_add_u32 s31, s31, 4096
    s_waitcnt lgkmcnt(5)
    v_mfma_f32_16x16x32_bf16 v[48:51], v[72:75], v[96:99], v[48:51]
    v_mfma_f32_16x16x32_bf16 v[52:55], v[72:75], v[100:103], v[52:55]
    s_waitcnt lgkmcnt(0)
    s_barrier
    s_waitcnt vmcnt(8)
    v_mfma_f32_16x16x32_bf16 v[16:19], v[76:79], v[104:107], v[16:19]
    ds_read_b128 v[56:59], v168 offset:0
    v_mfma_f32_16x16x32_bf16 v[20:23], v[76:79], v[108:111], v[20:23]
    ds_read_b128 v[60:63], v168 offset:1024
    v_mfma_f32_16x16x32_bf16 v[24:27], v[80:83], v[104:107], v[24:27]
    ds_read_b128 v[64:67], v169 offset:2048
    v_mfma_f32_16x16x32_bf16 v[28:31], v[80:83], v[108:111], v[28:31]
    ds_read_b128 v[68:71], v169 offset:3072
    v_mfma_f32_16x16x32_bf16 v[32:35], v[84:87], v[104:107], v[32:35]
    ds_read_b128 v[72:75], v169 offset:4096
    v_mfma_f32_16x16x32_bf16 v[36:39], v[84:87], v[108:111], v[36:39]
    buffer_load_dwordx4 v[144:147], v2, s[8:11], s27 offen offset:0 sc1
    v_mfma_f32_16x16x32_bf16 v[40:43], v[88:91], v[104:107], v[40:43]
    v_mfma_f32_16x16x32_bf16 v[44:47], v[88:91], v[108:111], v[44:47]
    buffer_load_dwordx4 v[148:151], v2, s[8:11], s31 offen offset:0 sc1
    v_mfma_f32_16x16x32_bf16 v[48:51], v[92:95], v[104:107], v[48:51]
    v_mfma_f32_16x16x32_bf16 v[52:55], v[92:95], v[108:111], v[52:55]
    s_waitcnt vmcnt(8)
    s_waitcnt lgkmcnt(4)
    v_mfma_f32_16x16x32_bf16 v[16:19], v[56:59], v[112:115], v[16:19]
    ds_read_b128 v[76:79], v169 offset:5120
    v_mfma_f32_16x16x32_bf16 v[20:23], v[56:59], v[116:119], v[20:23]
    ds_read_b128 v[80:83], v169 offset:6144
    s_waitcnt lgkmcnt(5)
    v_mfma_f32_16x16x32_bf16 v[24:27], v[60:63], v[112:115], v[24:27]
    ds_read_b128 v[84:87], v169 offset:7168
    v_mfma_f32_16x16x32_bf16 v[28:31], v[60:63], v[116:119], v[28:31]
    ds_read_b128 v[88:91], v169 offset:8192
    s_waitcnt lgkmcnt(6)
    v_mfma_f32_16x16x32_bf16 v[32:35], v[64:67], v[112:115], v[32:35]
    ds_read_b128 v[92:95], v169 offset:9216
    v_mfma_f32_16x16x32_bf16 v[36:39], v[64:67], v[116:119], v[36:39]
    buffer_load_dwordx4 v[152:155], v2, s[8:11], s27 offen offset:2048 sc1
    s_waitcnt lgkmcnt(6)
    v_mfma_f32_16x16x32_bf16 v[40:43], v[68:71], v[112:115], v[40:43]
    v_mfma_f32_16x16x32_bf16 v[44:47], v[68:71], v[116:119], v[44:47]
    buffer_load_dwordx4 v[156:159], v2, s[8:11], s31 offen offset:2048 sc1
    s_add_u32 s27, s27, 4096
    s_add_u32 s31, s31, 4096
    s_waitcnt lgkmcnt(5)
    v_mfma_f32_16x16x32_bf16 v[48:51], v[72:75], v[112:115], v[48:51]
    v_mfma_f32_16x16x32_bf16 v[52:55], v[72:75], v[116:119], v[52:55]
    s_waitcnt lgkmcnt(0)
    s_barrier
    s_waitcnt vmcnt(8)
    v_mfma_f32_16x16x32_bf16 v[16:19], v[76:79], v[120:123], v[16:19]
    ds_read_b128 v[56:59], v170 offset:0
    v_mfma_f32_16x16x32_bf16 v[20:23], v[76:79], v[124:127], v[20:23]
    ds_read_b128 v[60:63], v170 offset:1024
    v_mfma_f32_16x16x32_bf16 v[24:27], v[80:83], v[120:123], v[24:27]
    ds_read_b128 v[64:67], v171 offset:2048
    v_mfma_f32_16x16x32_bf16 v[28:31], v[80:83], v[124:127], v[28:31]
    ds_read_b128 v[68:71], v171 offset:3072
    v_mfma_f32_16x16x32_bf16 v[32:35], v[84:87], v[120:123], v[32:35]
    ds_read_b128 v[72:75], v171 offset:4096
    v_mfma_f32_16x16x32_bf16 v[36:39], v[84:87], v[124:127], v[36:39]
    buffer_load_dwordx4 v[96:99], v2, s[8:11], s27 offen offset:0 sc1
    v_mfma_f32_16x16x32_bf16 v[40:43], v[88:91], v[120:123], v[40:43]
    v_mfma_f32_16x16x32_bf16 v[44:47], v[88:91], v[124:127], v[44:47]
    buffer_load_dwordx4 v[100:103], v2, s[8:11], s31 offen offset:0 sc1
    v_mfma_f32_16x16x32_bf16 v[48:51], v[92:95], v[120:123], v[48:51]
    v_mfma_f32_16x16x32_bf16 v[52:55], v[92:95], v[124:127], v[52:55]
    s_waitcnt vmcnt(8)
    s_waitcnt lgkmcnt(4)
    v_mfma_f32_16x16x32_bf16 v[16:19], v[56:59], v[128:131], v[16:19]
    ds_read_b128 v[76:79], v171 offset:5120
    v_mfma_f32_16x16x32_bf16 v[20:23], v[56:59], v[132:135], v[20:23]
    ds_read_b128 v[80:83], v171 offset:6144
    s_waitcnt lgkmcnt(5)
    v_mfma_f32_16x16x32_bf16 v[24:27], v[60:63], v[128:131], v[24:27]
    ds_read_b128 v[84:87], v171 offset:7168
    v_mfma_f32_16x16x32_bf16 v[28:31], v[60:63], v[132:135], v[28:31]
    ds_read_b128 v[88:91], v171 offset:8192
    s_waitcnt lgkmcnt(6)
    v_mfma_f32_16x16x32_bf16 v[32:35], v[64:67], v[128:131], v[32:35]
    ds_read_b128 v[92:95], v171 offset:9216
    v_mfma_f32_16x16x32_bf16 v[36:39], v[64:67], v[132:135], v[36:39]
    buffer_load_dwordx4 v[104:107], v2, s[8:11], s27 offen offset:2048 sc1
    s_waitcnt lgkmcnt(6)
    v_mfma_f32_16x16x32_bf16 v[40:43], v[68:71], v[128:131], v[40:43]
    v_mfma_f32_16x16x32_bf16 v[44:47], v[68:71], v[132:135], v[44:47]
    buffer_load_dwordx4 v[108:111], v2, s[8:11], s31 offen offset:2048 sc1
    s_add_u32 s27, s27, 4096
    s_add_u32 s31, s31, 4096
    s_waitcnt lgkmcnt(5)
    v_mfma_f32_16x16x32_bf16 v[48:51], v[72:75], v[128:131], v[48:51]
    v_mfma_f32_16x16x32_bf16 v[52:55], v[72:75], v[132:135], v[52:55]
    s_waitcnt lgkmcnt(0)
    s_barrier
    s_waitcnt vmcnt(8)
    v_mfma_f32_16x16x32_bf16 v[16:19], v[76:79], v[136:139], v[16:19]
    ds_read_b128 v[56:59], v172 offset:0
    v_mfma_f32_16x16x32_bf16 v[20:23], v[76:79], v[140:143], v[20:23]
    ds_read_b128 v[60:63], v172 offset:1024
    v_mfma_f32_16x16x32_bf16 v[24:27], v[80:83], v[136:139], v[24:27]
    ds_read_b128 v[64:67], v173 offset:2048
    v_mfma_f32_16x16x32_bf16 v[28:31], v[80:83], v[140:143], v[28:31]
    ds_read_b128 v[68:71], v173 offset:3072
    v_mfma_f32_16x16x32_bf16 v[32:35], v[84:87], v[136:139], v[32:35]
    ds_read_b128 v[72:75], v173 offset:4096
    v_mfma_f32_16x16x32_bf16 v[36:39], v[84:87], v[140:143], v[36:39]
    buffer_load_dwordx4 v[112:115], v2, s[8:11], s27 offen offset:0 sc1
    v_mfma_f32_16x16x32_bf16 v[40:43], v[88:91], v[136:139], v[40:43]
    v_mfma_f32_16x16x32_bf16 v[44:47], v[88:91], v[140:143], v[44:47]
    buffer_load_dwordx4 v[116:119], v2, s[8:11], s31 offen offset:0 sc1
    v_mfma_f32_16x16x32_bf16 v[48:51], v[92:95], v[136:139], v[48:51]
    v_mfma_f32_16x16x32_bf16 v[52:55], v[92:95], v[140:143], v[52:55]
    s_waitcnt vmcnt(8)
    s_waitcnt lgkmcnt(4)
    v_mfma_f32_16x16x32_bf16 v[16:19], v[56:59], v[144:147], v[16:19]
    ds_read_b128 v[76:79], v173 offset:5120
    v_mfma_f32_16x16x32_bf16 v[20:23], v[56:59], v[148:151], v[20:23]
    ds_read_b128 v[80:83], v173 offset:6144
    s_waitcnt lgkmcnt(5)
    v_mfma_f32_16x16x32_bf16 v[24:27], v[60:63], v[144:147], v[24:27]
    ds_read_b128 v[84:87], v173 offset:7168
    v_mfma_f32_16x16x32_bf16 v[28:31], v[60:63], v[148:151], v[28:31]
    ds_read_b128 v[88:91], v173 offset:8192
    s_waitcnt lgkmcnt(6)
    v_mfma_f32_16x16x32_bf16 v[32:35], v[64:67], v[144:147], v[32:35]
    ds_read_b128 v[92:95], v173 offset:9216
    v_mfma_f32_16x16x32_bf16 v[36:39], v[64:67], v[148:151], v[36:39]
    buffer_load_dwordx4 v[120:123], v2, s[8:11], s27 offen offset:2048 sc1
    s_waitcnt lgkmcnt(6)
    v_mfma_f32_16x16x32_bf16 v[40:43], v[68:71], v[144:147], v[40:43]
    v_mfma_f32_16x16x32_bf16 v[44:47], v[68:71], v[148:151], v[44:47]
    buffer_load_dwordx4 v[124:127], v2, s[8:11], s31 offen offset:2048 sc1
    s_add_u32 s27, s27, 4096
    s_add_u32 s31, s31, 4096
    s_waitcnt lgkmcnt(5)
    v_mfma_f32_16x16x32_bf16 v[48:51], v[72:75], v[144:147], v[48:51]
    v_mfma_f32_16x16x32_bf16 v[52:55], v[72:75], v[148:151], v[52:55]
    s_waitcnt lgkmcnt(0)
    s_barrier
    s_waitcnt vmcnt(8)
    v_mfma_f32_16x16x32_bf16 v[16:19], v[76:79], v[152:155], v[16:19]
    ds_read_b128 v[56:59], v160 offset:0
    v_mfma_f32_16x16x32_bf16 v[20:23], v[76:79], v[156:159], v[20:23]
    ds_read_b128 v[60:63], v160 offset:1024
    v_mfma_f32_16x16x32_bf16 v[24:27], v[80:83], v[152:155], v[24:27]
    ds_read_b128 v[64:67], v161 offset:2048
    v_mfma_f32_16x16x32_bf16 v[28:31], v[80:83], v[156:159], v[28:31]
    ds_read_b128 v[68:71], v161 offset:3072
    v_mfma_f32_16x16x32_bf16 v[32:35], v[84:87], v[152:155], v[32:35]
    ds_read_b128 v[72:75], v161 offset:4096
    v_mfma_f32_16x16x32_bf16 v[36:39], v[84:87], v[156:159], v[36:39]
    buffer_load_dwordx4 v[128:131], v2, s[8:11], s27 offen offset:0 sc1
    v_mfma_f32_16x16x32_bf16 v[40:43], v[88:91], v[152:155], v[40:43]
    v_mfma_f32_16x16x32_bf16 v[44:47], v[88:91], v[156:159], v[44:47]
    buffer_load_dwordx4 v[132:135], v2, s[8:11], s31 offen offset:0 sc1
    v_mfma_f32_16x16x32_bf16 v[48:51], v[92:95], v[152:155], v[48:51]
    v_mfma_f32_16x16x32_bf16 v[52:55], v[92:95], v[156:159], v[52:55]
    s_waitcnt vmcnt(8)
    s_waitcnt lgkmcnt(4)
    v_mfma_f32_16x16x32_bf16 v[16:19], v[56:59], v[96:99], v[16:19]
    ds_read_b128 v[76:79], v161 offset:5120
    v_mfma_f32_16x16x32_bf16 v[20:23], v[56:59], v[100:103], v[20:23]
    ds_read_b128 v[80:83], v161 offset:6144
    s_waitcnt lgkmcnt(5)
    v_mfma_f32_16x16x32_bf16 v[24:27], v[60:63], v[96:99], v[24:27]
    ds_read_b128 v[84:87], v161 offset:7168
    v_mfma_f32_16x16x32_bf16 v[28:31], v[60:63], v[100:103], v[28:31]
    ds_read_b128 v[88:91], v161 offset:8192
    s_waitcnt lgkmcnt(6)
    v_mfma_f32_16x16x32_bf16 v[32:35], v[64:67], v[96:99], v[32:35]
    ds_read_b128 v[92:95], v161 offset:9216
    v_mfma_f32_16x16x32_bf16 v[36:39], v[64:67], v[100:103], v[36:39]
    buffer_load_dwordx4 v[136:139], v2, s[8:11], s27 offen offset:2048 sc1
    s_waitcnt lgkmcnt(6)
    v_mfma_f32_16x16x32_bf16 v[40:43], v[68:71], v[96:99], v[40:43]
    v_mfma_f32_16x16x32_bf16 v[44:47], v[68:71], v[100:103], v[44:47]
    buffer_load_dwordx4 v[140:143], v2, s[8:11], s31 offen offset:2048 sc1
    s_add_u32 s27, s27, 4096
    s_add_u32 s31, s31, 4096
    s_waitcnt lgkmcnt(5)
    v_mfma_f32_16x16x32_bf16 v[48:51], v[72:75], v[96:99], v[48:51]
    v_mfma_f32_16x16x32_bf16 v[52:55], v[72:75], v[100:103], v[52:55]
    s_waitcnt lgkmcnt(0)
    s_barrier
    s_waitcnt vmcnt(8)
    v_mfma_f32_16x16x32_bf16 v[16:19], v[76:79], v[104:107], v[16:19]
    ds_read_b128 v[56:59], v162 offset:0
    v_mfma_f32_16x16x32_bf16 v[20:23], v[76:79], v[108:111], v[20:23]
    ds_read_b128 v[60:63], v162 offset:1024
    v_mfma_f32_16x16x32_bf16 v[24:27], v[80:83], v[104:107], v[24:27]
    ds_read_b128 v[64:67], v163 offset:2048
    v_mfma_f32_16x16x32_bf16 v[28:31], v[80:83], v[108:111], v[28:31]
    ds_read_b128 v[68:71], v163 offset:3072
    v_mfma_f32_16x16x32_bf16 v[32:35], v[84:87], v[104:107], v[32:35]
    ds_read_b128 v[72:75], v163 offset:4096
    v_mfma_f32_16x16x32_bf16 v[36:39], v[84:87], v[108:111], v[36:39]
    buffer_load_dwordx4 v[144:147], v2, s[8:11], s27 offen offset:0 sc1
    v_mfma_f32_16x16x32_bf16 v[40:43], v[88:91], v[104:107], v[40:43]
    v_mfma_f32_16x16x32_bf16 v[44:47], v[88:91], v[108:111], v[44:47]
    buffer_load_dwordx4 v[148:151], v2, s[8:11], s31 offen offset:0 sc1
    v_mfma_f32_16x16x32_bf16 v[48:51], v[92:95], v[104:107], v[48:51]
    v_mfma_f32_16x16x32_bf16 v[52:55], v[92:95], v[108:111], v[52:55]
    s_waitcnt vmcnt(8)
    s_waitcnt lgkmcnt(4)
    v_mfma_f32_16x16x32_bf16 v[16:19], v[56:59], v[112:115], v[16:19]
    ds_read_b128 v[76:79], v163 offset:5120
    v_mfma_f32_16x16x32_bf16 v[20:23], v[56:59], v[116:119], v[20:23]
    ds_read_b128 v[80:83], v163 offset:6144
    s_waitcnt lgkmcnt(5)
    v_mfma_f32_16x16x32_bf16 v[24:27], v[60:63], v[112:115], v[24:27]
    ds_read_b128 v[84:87], v163 offset:7168
    v_mfma_f32_16x16x32_bf16 v[28:31], v[60:63], v[116:119], v[28:31]
    ds_read_b128 v[88:91], v163 offset:8192
    s_waitcnt lgkmcnt(6)
    v_mfma_f32_16x16x32_bf16 v[32:35], v[64:67], v[112:115], v[32:35]
    ds_read_b128 v[92:95], v163 offset:9216
    v_mfma_f32_16x16x32_bf16 v[36:39], v[64:67], v[116:119], v[36:39]
    buffer_load_dwordx4 v[152:155], v2, s[8:11], s27 offen offset:2048 sc1
    s_waitcnt lgkmcnt(6)
    v_mfma_f32_16x16x32_bf16 v[40:43], v[68:71], v[112:115], v[40:43]
    v_mfma_f32_16x16x32_bf16 v[44:47], v[68:71], v[116:119], v[44:47]
    buffer_load_dwordx4 v[156:159], v2, s[8:11], s31 offen offset:2048 sc1
    s_waitcnt lgkmcnt(5)
    v_mfma_f32_16x16x32_bf16 v[48:51], v[72:75], v[112:115], v[48:51]
    v_mfma_f32_16x16x32_bf16 v[52:55], v[72:75], v[116:119], v[52:55]
    s_waitcnt lgkmcnt(0)
    s_barrier
    s_waitcnt vmcnt(8)
    v_mfma_f32_16x16x32_bf16 v[16:19], v[76:79], v[120:123], v[16:19]
    ds_read_b128 v[56:59], v164 offset:0
    v_mfma_f32_16x16x32_bf16 v[20:23], v[76:79], v[124:127], v[20:23]
    ds_read_b128 v[60:63], v164 offset:1024
    v_mfma_f32_16x16x32_bf16 v[24:27], v[80:83], v[120:123], v[24:27]
    ds_read_b128 v[64:67], v165 offset:2048
    v_mfma_f32_16x16x32_bf16 v[28:31], v[80:83], v[124:127], v[28:31]
    ds_read_b128 v[68:71], v165 offset:3072
    v_mfma_f32_16x16x32_bf16 v[32:35], v[84:87], v[120:123], v[32:35]
    ds_read_b128 v[72:75], v165 offset:4096
    v_mfma_f32_16x16x32_bf16 v[36:39], v[84:87], v[124:127], v[36:39]
    v_mfma_f32_16x16x32_bf16 v[40:43], v[88:91], v[120:123], v[40:43]
    v_mfma_f32_16x16x32_bf16 v[44:47], v[88:91], v[124:127], v[44:47]
    v_mfma_f32_16x16x32_bf16 v[48:51], v[92:95], v[120:123], v[48:51]
    v_mfma_f32_16x16x32_bf16 v[52:55], v[92:95], v[124:127], v[52:55]
    s_waitcnt vmcnt(6)
    s_waitcnt lgkmcnt(4)
    v_mfma_f32_16x16x32_bf16 v[16:19], v[56:59], v[128:131], v[16:19]
    ds_read_b128 v[76:79], v165 offset:5120
    v_mfma_f32_16x16x32_bf16 v[20:23], v[56:59], v[132:135], v[20:23]
    ds_read_b128 v[80:83], v165 offset:6144
    s_waitcnt lgkmcnt(5)
    v_mfma_f32_16x16x32_bf16 v[24:27], v[60:63], v[128:131], v[24:27]
    ds_read_b128 v[84:87], v165 offset:7168
    v_mfma_f32_16x16x32_bf16 v[28:31], v[60:63], v[132:135], v[28:31]
    ds_read_b128 v[88:91], v165 offset:8192
    s_waitcnt lgkmcnt(6)
    v_mfma_f32_16x16x32_bf16 v[32:35], v[64:67], v[128:131], v[32:35]
    ds_read_b128 v[92:95], v165 offset:9216
    v_mfma_f32_16x16x32_bf16 v[36:39], v[64:67], v[132:135], v[36:39]
    s_waitcnt lgkmcnt(6)
    v_mfma_f32_16x16x32_bf16 v[40:43], v[68:71], v[128:131], v[40:43]
    v_mfma_f32_16x16x32_bf16 v[44:47], v[68:71], v[132:135], v[44:47]
    s_waitcnt lgkmcnt(5)
    v_mfma_f32_16x16x32_bf16 v[48:51], v[72:75], v[128:131], v[48:51]
    v_mfma_f32_16x16x32_bf16 v[52:55], v[72:75], v[132:135], v[52:55]
    s_waitcnt lgkmcnt(0)
    s_barrier
    s_waitcnt vmcnt(4)
    v_mfma_f32_16x16x32_bf16 v[16:19], v[76:79], v[136:139], v[16:19]
    ds_read_b128 v[56:59], v166 offset:0
    v_mfma_f32_16x16x32_bf16 v[20:23], v[76:79], v[140:143], v[20:23]
    ds_read_b128 v[60:63], v166 offset:1024
    v_mfma_f32_16x16x32_bf16 v[24:27], v[80:83], v[136:139], v[24:27]
    ds_read_b128 v[64:67], v167 offset:2048
    v_mfma_f32_16x16x32_bf16 v[28:31], v[80:83], v[140:143], v[28:31]
    ds_read_b128 v[68:71], v167 offset:3072
    v_mfma_f32_16x16x32_bf16 v[32:35], v[84:87], v[136:139], v[32:35]
    ds_read_b128 v[72:75], v167 offset:4096
    v_mfma_f32_16x16x32_bf16 v[36:39], v[84:87], v[140:143], v[36:39]
    v_mfma_f32_16x16x32_bf16 v[40:43], v[88:91], v[136:139], v[40:43]
    v_mfma_f32_16x16x32_bf16 v[44:47], v[88:91], v[140:143], v[44:47]
    v_mfma_f32_16x16x32_bf16 v[48:51], v[92:95], v[136:139], v[48:51]
    v_mfma_f32_16x16x32_bf16 v[52:55], v[92:95], v[140:143], v[52:55]
    s_waitcnt vmcnt(2)
    s_waitcnt lgkmcnt(4)
    v_mfma_f32_16x16x32_bf16 v[16:19], v[56:59], v[144:147], v[16:19]
    ds_read_b128 v[76:79], v167 offset:5120
    v_mfma_f32_16x16x32_bf16 v[20:23], v[56:59], v[148:151], v[20:23]
    ds_read_b128 v[80:83], v167 offset:6144
    s_waitcnt lgkmcnt(5)
    v_mfma_f32_16x16x32_bf16 v[24:27], v[60:63], v[144:147], v[24:27]
    ds_read_b128 v[84:87], v167 offset:7168
    v_mfma_f32_16x16x32_bf16 v[28:31], v[60:63], v[148:151], v[28:31]
    ds_read_b128 v[88:91], v167 offset:8192
    s_waitcnt lgkmcnt(6)
    v_mfma_f32_16x16x32_bf16 v[32:35], v[64:67], v[144:147], v[32:35]
    ds_read_b128 v[92:95], v167 offset:9216
    v_mfma_f32_16x16x32_bf16 v[36:39], v[64:67], v[148:151], v[36:39]
    s_waitcnt lgkmcnt(6)
    v_mfma_f32_16x16x32_bf16 v[40:43], v[68:71], v[144:147], v[40:43]
    v_mfma_f32_16x16x32_bf16 v[44:47], v[68:71], v[148:151], v[44:47]
    s_waitcnt lgkmcnt(5)
    v_mfma_f32_16x16x32_bf16 v[48:51], v[72:75], v[144:147], v[48:51]
    v_mfma_f32_16x16x32_bf16 v[52:55], v[72:75], v[148:151], v[52:55]
    s_waitcnt vmcnt(0)
    s_waitcnt lgkmcnt(4)
    v_mfma_f32_16x16x32_bf16 v[20:23], v[76:79], v[156:159], v[20:23]
    ds_read_b64_tr_b16 v[56:57], v7 offset:0
    s_waitcnt lgkmcnt(4)
    v_mfma_f32_16x16x32_bf16 v[28:31], v[80:83], v[156:159], v[28:31]
    ds_read_b64_tr_b16 v[58:59], v7 offset:2048
    s_waitcnt lgkmcnt(4)
    v_mfma_f32_16x16x32_bf16 v[36:39], v[84:87], v[156:159], v[36:39]
    ds_read_b64_tr_b16 v[60:61], v7 offset:4096
    s_waitcnt lgkmcnt(4)
    v_mfma_f32_16x16x32_bf16 v[44:47], v[88:91], v[156:159], v[44:47]
    ds_read_b64_tr_b16 v[62:63], v7 offset:6144
    s_waitcnt lgkmcnt(4)
    v_mfma_f32_16x16x32_bf16 v[52:55], v[92:95], v[156:159], v[52:55]
    ds_read_b64_tr_b16 v[64:65], v7 offset:8192
    v_mfma_f32_16x16x32_bf16 v[16:19], v[76:79], v[152:155], v[16:19]
    ds_write_b128 v11, v[20:23] offset:0
    v_mfma_f32_16x16x32_bf16 v[24:27], v[80:83], v[152:155], v[24:27]
    ds_write_b128 v11, v[28:31] offset:1024
    v_mfma_f32_16x16x32_bf16 v[32:35], v[84:87], v[152:155], v[32:35]
    ds_write_b128 v11, v[36:39] offset:2048
    v_mfma_f32_16x16x32_bf16 v[40:43], v[88:91], v[152:155], v[40:43]
    ds_write_b128 v11, v[44:47] offset:3072
    v_mfma_f32_16x16x32_bf16 v[48:51], v[92:95], v[152:155], v[48:51]
    ds_write_b128 v11, v[52:55] offset:4096
    s_waitcnt lgkmcnt(5)
    v_lshlrev_b32 v116, 16, v56
    v_lshlrev_b32 v120, 16, v58
    v_lshlrev_b32 v124, 16, v60
    v_lshlrev_b32 v128, 16, v62
    v_lshlrev_b32 v132, 16, v64
    v_and_b32 v117, 0xffff0000, v56
    v_and_b32 v121, 0xffff0000, v58
    v_and_b32 v125, 0xffff0000, v60
    v_and_b32 v129, 0xffff0000, v62
    v_and_b32 v133, 0xffff0000, v64
    v_lshlrev_b32 v118, 16, v57
    v_lshlrev_b32 v122, 16, v59
    v_lshlrev_b32 v126, 16, v61
    v_lshlrev_b32 v130, 16, v63
    v_lshlrev_b32 v134, 16, v65
    v_and_b32 v119, 0xffff0000, v57
    v_and_b32 v123, 0xffff0000, v59
    v_and_b32 v127, 0xffff0000, v61
    v_and_b32 v131, 0xffff0000, v63
    v_and_b32 v135, 0xffff0000, v65
    s_waitcnt lgkmcnt(0)
    s_barrier
    ds_read_b128 v[96:99], v12 offset:0
    ds_read_b128 v[100:103], v12 offset:1024
    ds_read_b128 v[104:107], v12 offset:2048
    ds_read_b128 v[108:111], v12 offset:3072
    ds_read_b128 v[112:115], v12 offset:4096
    v_add_f32 v16, v16, v116
    v_add_f32 v17, v17, v117
    v_add_f32 v18, v18, v118
    v_add_f32 v19, v19, v119
    v_add_f32 v24, v24, v120
    v_add_f32 v25, v25, v121
    v_add_f32 v26, v26, v122
    v_add_f32 v27, v27, v123
    v_add_f32 v32, v32, v124
    v_add_f32 v33, v33, v125
    v_add_f32 v34, v34, v126
    v_add_f32 v35, v35, v127
    v_add_f32 v40, v40, v128
    v_add_f32 v41, v41, v129
    v_add_f32 v42, v42, v130
    v_add_f32 v43, v43, v131
    v_add_f32 v48, v48, v132
    v_add_f32 v49, v49, v133
    v_add_f32 v50, v50, v134
    v_add_f32 v51, v51, v135
    s_waitcnt lgkmcnt(0)
    s_bitcmp1_b32 s99, 0
    s_cbranch_scc1 L_g2_odd_26
    v_add_f32 v16, v16, v96
    v_add_f32 v24, v24, v100
    v_add_f32 v17, v17, v97
    v_add_f32 v25, v25, v101
    v_add_f32 v18, v18, v98
    v_add_f32 v26, v26, v102
    v_add_f32 v19, v19, v99
    v_add_f32 v27, v27, v103
    v_cvt_pk_bf16_f32 v140, v16, v17
    v_cvt_pk_bf16_f32 v142, v24, v25
    v_cvt_pk_bf16_f32 v141, v18, v19
    v_cvt_pk_bf16_f32 v143, v26, v27
    v_permlane16_swap_b32 v140, v142
    s_nop 0
    v_permlane16_swap_b32 v141, v143
    buffer_store_dwordx4 v[140:143], v8, s[12:15], s28 offen offset:0 sc1
    v_add_f32 v32, v32, v104
    v_add_f32 v40, v40, v108
    v_add_f32 v33, v33, v105
    v_add_f32 v41, v41, v109
    v_add_f32 v34, v34, v106
    v_add_f32 v42, v42, v110
    v_add_f32 v35, v35, v107
    v_add_f32 v43, v43, v111
    v_cvt_pk_bf16_f32 v144, v32, v33
    v_cvt_pk_bf16_f32 v146, v40, v41
    v_cvt_pk_bf16_f32 v145, v34, v35
    v_cvt_pk_bf16_f32 v147, v42, v43
    v_permlane16_swap_b32 v144, v146
    s_nop 0
    v_permlane16_swap_b32 v145, v147
    buffer_store_dwordx4 v[144:147], v8, s[12:15], s28 offen offset:64 sc1
    v_add_f32 v48, v48, v112
    v_add_f32 v49, v49, v113
    v_add_f32 v50, v50, v114
    v_add_f32 v51, v51, v115
    v_cvt_pk_bf16_f32 v148, v48, v49
    v_cvt_pk_bf16_f32 v149, v50, v51
    buffer_store_dwordx2 v[148:149], v9, s[12:15], s28 offen offset:128 sc1
    s_branch L_end_1
L_g2_odd_26:
    v_add_f32 v24, v24, v100
    v_add_f32 v32, v32, v104
    v_add_f32 v25, v25, v101
    v_add_f32 v33, v33, v105
    v_add_f32 v26, v26, v102
    v_add_f32 v34, v34, v106
    v_add_f32 v27, v27, v103
    v_add_f32 v35, v35, v107
    v_cvt_pk_bf16_f32 v140, v24, v25
    v_cvt_pk_bf16_f32 v142, v32, v33
    v_cvt_pk_bf16_f32 v141, v26, v27
    v_cvt_pk_bf16_f32 v143, v34, v35
    v_permlane16_swap_b32 v140, v142
    s_nop 0
    v_permlane16_swap_b32 v141, v143
    buffer_store_dwordx4 v[140:143], v8, s[12:15], s28 offen offset:32 sc1
    v_add_f32 v40, v40, v108
    v_add_f32 v48, v48, v112
    v_add_f32 v41, v41, v109
    v_add_f32 v49, v49, v113
    v_add_f32 v42, v42, v110
    v_add_f32 v50, v50, v114
    v_add_f32 v43, v43, v111
    v_add_f32 v51, v51, v115
    v_cvt_pk_bf16_f32 v144, v40, v41
    v_cvt_pk_bf16_f32 v146, v48, v49
    v_cvt_pk_bf16_f32 v145, v42, v43
    v_cvt_pk_bf16_f32 v147, v50, v51
    v_permlane16_swap_b32 v144, v146
    s_nop 0
    v_permlane16_swap_b32 v145, v147
    buffer_store_dwordx4 v[144:147], v8, s[12:15], s28 offen offset:96 sc1
    v_add_f32 v16, v16, v96
    v_add_f32 v17, v17, v97
    v_add_f32 v18, v18, v98
    v_add_f32 v19, v19, v99
    v_cvt_pk_bf16_f32 v148, v16, v17
    v_cvt_pk_bf16_f32 v149, v18, v19
    buffer_store_dwordx2 v[148:149], v9, s[12:15], s28 offen offset:0 sc1
    s_branch L_end_1
L_lnrest_9:
    s_mov_b32 s8, s4
    s_and_b32 s9, s5, 0xffff
    s_mov_b32 s10, 268435456
    s_mov_b32 s11, 0x20000
    v_lshl_add_u32 v5, v1, 4, s52
    v_bfe_u32 v6, v1, 4, 1
    v_lshrrev_b32 v7, 5, v1
    v_bfe_u32 v8, v1, 2, 2
    v_lshl_add_u32 v8, v7, 3, v8
    v_lshlrev_b32 v8, 6, v8
    v_lshl_add_u32 v8, v6, 5, v8
    v_lshl_add_u32 v8, v4, 3, v8
    v_add_u32 v8, s52, v8
    v_and_b32 v9, 15, v1
    v_lshl_add_u32 v9, v6, 4, v9
    v_lshlrev_b32 v9, 5, v9
    v_lshl_add_u32 v9, v7, 4, v9
    s_add_u32 s28, s26, 3670016
    v_add_u32 v10, 4096, v9
    v_mov_b32 v11, 0
    v_mov_b32 v12, 0
    v_mov_b32 v13, 0
    v_mov_b32 v14, 0
    s_mov_b32 s29, 0x3f803f80
    s_lshl_b32 s30, s23, 7
    s_add_u32 s30, s30, s53
    s_add_u32 s30, s30, 20480
    v_lshl_add_u32 v15, v2, 3, s30
    v_and_b32 v2, 15, v1
    v_lshlrev_b32 v3, 2, v2
    v_lshlrev_b32 v2, 3, v2
    v_add_u32 v2, s53, v2
    v_add_u32 v2, 20480, v2
    s_lshl_b32 s31, s19, 6
    s_add_u32 s30, s31, 131072
    s_add_u32 s31, s31, 4096
    s_waitcnt vmcnt(0)
    ds_read_b128 v[16:19], v5 offset:0
    ds_read_b128 v[20:23], v5 offset:1024
    ds_read_b128 v[24:27], v5 offset:2048
    ds_read_b128 v[28:31], v5 offset:3072
    ds_read_b128 v[32:35], v5 offset:4096
    ds_read_b64_tr_b16 v[36:37], v8 offset:0
    ds_read_b64_tr_b16 v[38:39], v8 offset:256
    ds_read_b64_tr_b16 v[40:41], v8 offset:1024
    ds_read_b64_tr_b16 v[42:43], v8 offset:1280
    ds_read_b64_tr_b16 v[44:45], v8 offset:2048
    ds_read_b64_tr_b16 v[46:47], v8 offset:2304
    ds_read_b64_tr_b16 v[48:49], v8 offset:3072
    ds_read_b64_tr_b16 v[50:51], v8 offset:3328
    ds_read_b64_tr_b16 v[52:53], v8 offset:4096
    ds_read_b64_tr_b16 v[54:55], v8 offset:4352
    s_waitcnt lgkmcnt(0)
    s_add_u32 s18, s18, 1
    buffer_store_dwordx4 v[36:39], v9, s[8:11], s28 offen offset:0 sc1
    v_dot2c_f32_bf16 v12, s29, v16
    v_dot2c_f32_bf16 v13, v16, v16
    v_dot2c_f32_bf16 v11, s29, v17
    v_dot2c_f32_bf16 v14, v17, v17
    v_dot2c_f32_bf16 v12, s29, v18
    v_dot2c_f32_bf16 v13, v18, v18
    v_dot2c_f32_bf16 v11, s29, v19
    v_dot2c_f32_bf16 v14, v19, v19
    buffer_store_dwordx4 v[40:43], v9, s[8:11], s28 offen offset:1024 sc1
    v_dot2c_f32_bf16 v12, s29, v20
    v_dot2c_f32_bf16 v13, v20, v20
    v_dot2c_f32_bf16 v11, s29, v21
    v_dot2c_f32_bf16 v14, v21, v21
    v_dot2c_f32_bf16 v12, s29, v22
    v_dot2c_f32_bf16 v13, v22, v22
    v_dot2c_f32_bf16 v11, s29, v23
    v_dot2c_f32_bf16 v14, v23, v23
    buffer_store_dwordx4 v[44:47], v9, s[8:11], s28 offen offset:2048 sc1
    v_dot2c_f32_bf16 v12, s29, v24
    v_dot2c_f32_bf16 v13, v24, v24
    v_dot2c_f32_bf16 v11, s29, v25
    v_dot2c_f32_bf16 v14, v25, v25
    v_dot2c_f32_bf16 v12, s29, v26
    v_dot2c_f32_bf16 v13, v26, v26
    v_dot2c_f32_bf16 v11, s29, v27
    v_dot2c_f32_bf16 v14, v27, v27
    buffer_store_dwordx4 v[48:51], v9, s[8:11], s28 offen offset:3072 sc1
    v_dot2c_f32_bf16 v12, s29, v28
    v_dot2c_f32_bf16 v13, v28, v28
    v_dot2c_f32_bf16 v11, s29, v29
    v_dot2c_f32_bf16 v14, v29, v29
    v_dot2c_f32_bf16 v12, s29, v30
    v_dot2c_f32_bf16 v13, v30, v30
    v_dot2c_f32_bf16 v11, s29, v31
    v_dot2c_f32_bf16 v14, v31, v31
    buffer_store_dwordx4 v[52:55], v10, s[8:11], s28 offen offset:0 sc1
    v_dot2c_f32_bf16 v12, s29, v32
    v_dot2c_f32_bf16 v13, v32, v32
    v_dot2c_f32_bf16 v11, s29, v33
    v_dot2c_f32_bf16 v14, v33, v33
    v_dot2c_f32_bf16 v12, s29, v34
    v_dot2c_f32_bf16 v13, v34, v34
    v_dot2c_f32_bf16 v11, s29, v35
    v_dot2c_f32_bf16 v14, v35, v35
    s_nop 1
    v_add_f32 v12, v11, v12
    v_add_f32 v13, v13, v14
    s_nop 0
    v_add_f32_dpp v12, v12, v12 quad_perm:[1,0,3,2] row_mask:0xf bank_mask:0xf
    v_add_f32_dpp v13, v13, v13 quad_perm:[1,0,3,2] row_mask:0xf bank_mask:0xf
    s_nop 0
    v_add_f32_dpp v12, v12, v12 quad_perm:[2,3,0,1] row_mask:0xf bank_mask:0xf
    v_add_f32_dpp v13, v13, v13 quad_perm:[2,3,0,1] row_mask:0xf bank_mask:0xf
    ds_write_b64 v15, v[12:13]
    v_mov_b32 v56, 158720
    v_mov_b32 v57, 1
    s_mov_b64 exec, 1
    ds_add_u32 v56, v57
    s_mov_b64 exec, -1
    s_cmp_lg_u32 s23, 0
    s_cbranch_scc1 L_lnw_29
    v_mov_b32 v56, 158720
    s_mov_b32 s59, 2097152
L_lw_30:
    ds_read_b32 v57, v56
    s_waitcnt lgkmcnt(0)
    v_readfirstlane_b32 s58, v57
    s_nop 0
    s_cmp_ge_u32 s58, 4
    s_cbranch_scc1 L_lwok_31
    s_sleep 1
    s_sub_u32 s59, s59, 1
    s_cmp_lg_u32 s59, 0
    s_cbranch_scc1 L_lw_30
L_lwok_31:
    ds_read_b64 v[56:57], v2 offset:0
    ds_read_b64 v[58:59], v2 offset:128
    ds_read_b64 v[60:61], v2 offset:256
    ds_read_b64 v[62:63], v2 offset:384
    s_waitcnt lgkmcnt(0)
    v_add_f32 v56, v56, v58
    v_add_f32 v57, v57, v59
    v_add_f32 v60, v60, v62
    v_add_f32 v61, v61, v63
    v_add_f32 v56, v56, v60
    v_add_f32 v57, v57, v61
    v_mul_f32 v56, 0x3acccccd, v56
    v_mul_f32 v57, 0x3acccccd, v57
    v_fma_f32 v57, -v56, v56, v57
    v_max_f32 v57, 0, v57
    v_cvt_pk_bf16_f32 v56, v56, v57
    v_and_b32 v57, 0xffff0000, v56
    v_lshlrev_b32 v56, 16, v56
    v_add_f32 v57, 0x3727c5ac, v57
    v_cvt_pk_bf16_f32 v57, v57, v57
    v_lshlrev_b32 v57, 16, v57
    v_sqrt_f32 v57, v57
    s_nop 0
    v_cvt_pk_bf16_f32 v57, v57, v57
    v_lshlrev_b32 v57, 16, v57
    v_lshrrev_b32 v57, 16, v57
    v_or_b32 v56, v56, v57
    s_mov_b32 exec_lo, 0xffff
    s_mov_b32 exec_hi, 0
    buffer_store_dword v56, v3, s[8:11], s30 offen sc1
    s_mov_b64 exec, -1
L_lnw_29:
    s_waitcnt vmcnt(0)
    v_mov_b32 v56, 158728
    v_mov_b32 v57, 1
    s_mov_b64 exec, 1
    ds_add_rtn_u32 v57, v56, v57
    s_mov_b64 exec, -1
    s_waitcnt lgkmcnt(0)
    v_readfirstlane_b32 s57, v57
    s_nop 0
    s_cmp_lg_u32 s57, 3
    s_cbranch_scc1 L_notlast_32
    v_mov_b32 v56, 0
    v_mov_b32 v57, s18
    s_mov_b64 exec, 1
    buffer_store_dword v57, v56, s[8:11], s31 offen sc1
    s_mov_b64 exec, -1
L_notlast_32:
    s_setprio 0
    s_cmp_ge_u32 s25, 20
    s_cbranch_scc1 L_hsetup_7
    s_branch L_lnd_28
L_help_3:
    s_load_dword s18, s[4:5], 0
    s_barrier
    s_mov_b32 s8, s4
    s_and_b32 s9, s5, 0xffff
    s_mov_b32 s10, 268435456
    s_mov_b32 s11, 0x20000
    s_waitcnt lgkmcnt(0)
    s_add_u32 s18, s18, 1
L_lnd_28:
    v_lshrrev_b32 v2, 3, v1
    v_mul_u32_u24 v2, 20480, v2
    v_bfe_u32 v3, v1, 1, 2
    v_lshrrev_b32 v10, 4, v1
    v_xor_b32 v3, v3, v10
    v_lshl_add_u32 v2, v3, 5, v2
    v_and_b32 v3, 1, v1
    v_lshl_add_u32 v2, v3, 4, v2
    s_mul_i32 s26, s24, 20
    s_add_u32 s26, s26, s25
    s_lshl_b32 s28, s26, 7
    s_mul_i32 s29, s23, 655360
    s_add_u32 s28, s28, s29
    s_add_u32 s28, s28, 3670016
    s_lshl_b32 s29, s23, 12
    s_lshl_b32 s30, s23, 11
    s_add_u32 s30, s30, 131072
    v_lshlrev_b32 v4, 6, v1
    v_lshlrev_b32 v6, 5, v1
    v_lshrrev_b32 v7, 1, v1
    v_lshlrev_b32 v7, 7, v7
    v_lshl_add_u32 v7, v3, 4, v7
    v_add_u32 v7, s29, v7
    v_bfe_u32 v8, v1, 2, 2
    v_xor_b32 v12, 0, v8
    v_lshl_add_u32 v12, v12, 5, v7
    v_add_u32 v12, 123136, v12
    v_xor_b32 v13, 1, v8
    v_lshl_add_u32 v13, v13, 5, v7
    v_add_u32 v13, 123136, v13
    v_xor_b32 v14, 2, v8
    v_lshl_add_u32 v14, v14, 5, v7
    v_add_u32 v14, 123136, v14
    v_xor_b32 v15, 3, v8
    v_lshl_add_u32 v15, v15, 5, v7
    v_add_u32 v15, 123136, v15
    s_lshl_b32 s31, s23, 11
    s_add_u32 s31, s31, 4096
    v_mov_b32 v22, 158748
    s_mov_b32 s59, 2097152
L_lw_33:
    ds_read_b32 v23, v22
    s_waitcnt lgkmcnt(0)
    v_readfirstlane_b32 s58, v23
    s_nop 0
    s_cmp_ge_u32 s58, 5
    s_cbranch_scc1 L_lwok_34
    s_sleep 1
    s_sub_u32 s59, s59, 1
    s_cmp_lg_u32 s59, 0
    s_cbranch_scc1 L_lw_33
L_lwok_34:
    s_mov_b32 exec_lo, 0xffffffff
    s_mov_b32 exec_hi, 0
    buffer_load_dword v22, v4, s[8:11], s31 offen sc1
    s_waitcnt vmcnt(0)
    s_mov_b32 exec_lo, 0xffffffff
    s_mov_b32 exec_hi, 0
    s_mov_b32 s59, 131072
L_poll_35:
    v_cmp_ne_u32 vcc, s18, v22
    s_nop 0
    s_and_b64 exec, exec, vcc
    s_cbranch_scc0 L_pollok_36
    s_sub_u32 s59, s59, 1
    s_cbranch_scc1 L_pollok_36
    buffer_load_dword v22, v4, s[8:11], s31 offen sc1
    s_waitcnt vmcnt(0)
    s_branch L_poll_35
L_pollok_36:
    s_mov_b64 exec, -1
    s_add_u32 m0, s29, 139520
    buffer_load_dwordx4 v[16:19], v6, s[8:11], s30 offen sc1
    buffer_load_dwordx4 v[20:23], v6, s[8:11], s30 offen offset:16 sc1
    buffer_load_dwordx4 v2, s[8:11], s28 offen sc1 lds
    s_add_u32 m0, m0, 1024
    s_add_u32 s28, s28, 163840
    buffer_load_dwordx4 v2, s[8:11], s28 offen sc1 lds
    s_add_u32 m0, m0, 1024
    s_add_u32 s28, s28, 163840
    buffer_load_dwordx4 v2, s[8:11], s28 offen sc1 lds
    s_add_u32 m0, m0, 1024
    s_add_u32 s28, s28, 163840
    buffer_load_dwordx4 v2, s[8:11], s28 offen sc1 lds
    s_waitcnt vmcnt(4)
    v_lshlrev_b32 v24, 16, v16
    v_lshlrev_b32 v25, 16, v17
    v_lshlrev_b32 v26, 16, v18
    v_lshlrev_b32 v27, 16, v19
    v_lshlrev_b32 v28, 16, v20
    v_lshlrev_b32 v29, 16, v21
    v_lshlrev_b32 v30, 16, v22
    v_lshlrev_b32 v31, 16, v23
    v_rcp_f32 v24, v24
    v_and_b32 v32, 0xffff0000, v16
    v_rcp_f32 v25, v25
    v_and_b32 v33, 0xffff0000, v17
    v_rcp_f32 v26, v26
    v_and_b32 v34, 0xffff0000, v18
    v_rcp_f32 v27, v27
    v_and_b32 v35, 0xffff0000, v19
    v_rcp_f32 v28, v28
    v_and_b32 v36, 0xffff0000, v20
    v_rcp_f32 v29, v29
    v_and_b32 v37, 0xffff0000, v21
    v_rcp_f32 v30, v30
    v_and_b32 v38, 0xffff0000, v22
    v_rcp_f32 v31, v31
    v_and_b32 v39, 0xffff0000, v23
    s_waitcnt vmcnt(0)
    ds_read_b128 v[40:43], v12 offset:16384
    ds_read_b128 v[44:47], v13 offset:16384
    ds_read_b128 v[48:51], v14 offset:16384
    ds_read_b128 v[52:55], v15 offset:16384
    v_mul_f32 v32, v32, v24
    v_mul_f32 v33, v33, v25
    v_mul_f32 v34, v34, v26
    v_mul_f32 v35, v35, v27
    v_mul_f32 v36, v36, v28
    v_mul_f32 v37, v37, v29
    v_mul_f32 v38, v38, v30
    v_mul_f32 v39, v39, v31
    s_waitcnt lgkmcnt(3)
    v_lshlrev_b32 v56, 16, v40
    v_and_b32 v57, 0xffff0000, v40
    v_lshlrev_b32 v58, 16, v41
    v_and_b32 v59, 0xffff0000, v41
    v_lshlrev_b32 v60, 16, v42
    v_and_b32 v61, 0xffff0000, v42
    v_lshlrev_b32 v62, 16, v43
    v_and_b32 v63, 0xffff0000, v43
    v_fma_f32 v56, v56, v24, -v32
    v_fma_f32 v57, v57, v25, -v33
    v_fma_f32 v58, v58, v26, -v34
    v_fma_f32 v59, v59, v27, -v35
    v_fma_f32 v60, v60, v28, -v36
    v_fma_f32 v61, v61, v29, -v37
    v_fma_f32 v62, v62, v30, -v38
    v_fma_f32 v63, v63, v31, -v39
    v_cvt_pk_bf16_f32 v40, v56, v57
    v_cvt_pk_bf16_f32 v41, v58, v59
    v_cvt_pk_bf16_f32 v42, v60, v61
    v_cvt_pk_bf16_f32 v43, v62, v63
    ds_write_b128 v12, v[40:43]
    s_waitcnt lgkmcnt(3)
    v_lshlrev_b32 v64, 16, v44
    v_and_b32 v65, 0xffff0000, v44
    v_lshlrev_b32 v66, 16, v45
    v_and_b32 v67, 0xffff0000, v45
    v_lshlrev_b32 v68, 16, v46
    v_and_b32 v69, 0xffff0000, v46
    v_lshlrev_b32 v70, 16, v47
    v_and_b32 v71, 0xffff0000, v47
    v_fma_f32 v64, v64, v24, -v32
    v_fma_f32 v65, v65, v25, -v33
    v_fma_f32 v66, v66, v26, -v34
    v_fma_f32 v67, v67, v27, -v35
    v_fma_f32 v68, v68, v28, -v36
    v_fma_f32 v69, v69, v29, -v37
    v_fma_f32 v70, v70, v30, -v38
    v_fma_f32 v71, v71, v31, -v39
    v_cvt_pk_bf16_f32 v44, v64, v65
    v_cvt_pk_bf16_f32 v45, v66, v67
    v_cvt_pk_bf16_f32 v46, v68, v69
    v_cvt_pk_bf16_f32 v47, v70, v71
    ds_write_b128 v13, v[44:47]
    s_waitcnt lgkmcnt(3)
    v_lshlrev_b32 v56, 16, v48
    v_and_b32 v57, 0xffff0000, v48
    v_lshlrev_b32 v58, 16, v49
    v_and_b32 v59, 0xffff0000, v49
    v_lshlrev_b32 v60, 16, v50
    v_and_b32 v61, 0xffff0000, v50
    v_lshlrev_b32 v62, 16, v51
    v_and_b32 v63, 0xffff0000, v51
    v_fma_f32 v56, v56, v24, -v32
    v_fma_f32 v57, v57, v25, -v33
    v_fma_f32 v58, v58, v26, -v34
    v_fma_f32 v59, v59, v27, -v35
    v_fma_f32 v60, v60, v28, -v36
    v_fma_f32 v61, v61, v29, -v37
    v_fma_f32 v62, v62, v30, -v38
    v_fma_f32 v63, v63, v31, -v39
    v_cvt_pk_bf16_f32 v48, v56, v57
    v_cvt_pk_bf16_f32 v49, v58, v59
    v_cvt_pk_bf16_f32 v50, v60, v61
    v_cvt_pk_bf16_f32 v51, v62, v63
    ds_write_b128 v14, v[48:51]
    s_waitcnt lgkmcnt(3)
    v_lshlrev_b32 v64, 16, v52
    v_and_b32 v65, 0xffff0000, v52
    v_lshlrev_b32 v66, 16, v53
    v_and_b32 v67, 0xffff0000, v53
    v_lshlrev_b32 v68, 16, v54
    v_and_b32 v69, 0xffff0000, v54
    v_lshlrev_b32 v70, 16, v55
    v_and_b32 v71, 0xffff0000, v55
    v_fma_f32 v64, v64, v24, -v32
    v_fma_f32 v65, v65, v25, -v33
    v_fma_f32 v66, v66, v26, -v34
    v_fma_f32 v67, v67, v27, -v35
    v_fma_f32 v68, v68, v28, -v36
    v_fma_f32 v69, v69, v29, -v37
    v_fma_f32 v70, v70, v30, -v38
    v_fma_f32 v71, v71, v31, -v39
    v_cvt_pk_bf16_f32 v52, v64, v65
    v_cvt_pk_bf16_f32 v53, v66, v67
    v_cvt_pk_bf16_f32 v54, v68, v69
    v_cvt_pk_bf16_f32 v55, v70, v71
    ds_write_b128 v15, v[52:55]
    s_waitcnt lgkmcnt(0)
    s_barrier
L_hsetup_7:
    v_lshlrev_b32 v2, 4, v1
    v_lshrrev_b32 v3, 4, v1
    v_and_b32 v4, 15, v1
    s_and_b32 s26, s23, 1
    s_lshl_b32 s27, s26, 3
    v_lshl_add_u32 v5, v3, 1, s27
    v_xor_b32 v5, v5, v4
    v_lshlrev_b32 v5, 4, v5
    v_lshl_add_u32 v5, v3, 12, v5
    s_lshl_b32 s26, s23, 11
    s_add_u32 s26, s26, 86016
    s_mul_i32 s27, s23, 3072
    s_mul_i32 s28, s22, 245760
    s_add_u32 s28, s28, s27
    s_add_u32 s28, s28, 8912896
    s_lshl_b32 s29, s23, 15
    s_lshl_b32 s30, s21, 8
    s_add_u32 s29, s29, s30
    s_add_u32 s29, s29, 6291456
    s_mul_i32 s30, s22, 5
    s_lshr_b32 s30, s30, 2
    s_mov_b32 s31, s30
    s_mov_b32 s32, s30
    s_mov_b32 s34, s99
    s_mul_i32 s35, s34, 245760
    s_mul_i32 s36, s23, 5120
    s_add_u32 s35, s35, s36
    s_add_u32 s35, s35, 13107200
    s_mul_i32 s37, s34, 80
    s_mul_i32 s38, s23, 24
    s_add_u32 s37, s37, s38
    s_lshl_b32 s37, s37, 12
    s_lshl_b32 s38, s98, 7
    s_add_u32 s37, s37, s38
    s_add_u32 s37, s37, 6291456
    s_mul_i32 s38, s23, 3072
    v_lshrrev_b32 v15, 3, v1
    v_lshlrev_b32 v15, 12, v15
    v_and_b32 v16, 7, v1
    v_lshl_add_u32 v15, v16, 4, v15
    v_and_b32 v7, 0xff, v0
    v_min_u32 v9, 191, v7
    v_lshrrev_b32 v8, 4, v9
    v_mul_u32_u24 v10, 43, v8
    v_lshrrev_b32 v10, 8, v10
    v_mul_u32_u24 v11, 6, v10
    v_sub_u32 v8, v8, v11
    v_mul_u32_u24 v11, 86, v8
    v_lshrrev_b32 v11, 8, v11
    v_mul_u32_u24 v12, 3, v11
    v_sub_u32 v8, v8, v12
    v_mul_u32_u24 v10, 3, v10
    v_add_u32 v8, v8, v10
    v_lshlrev_b32 v8, 6, v8
    v_mul_u32_u24 v11, 6144, v11
    v_add_u32 v8, v8, v11
    v_and_b32 v10, 15, v9
    v_lshl_add_u32 v8, v10, 2, v8
    s_mul_i32 s39, s22, 384
    s_add_u32 s39, s39, 524288
    v_lshlrev_b32 v9, 2, v9
    v_add_u32 v9, 143360, v9
    s_lshl_b32 s40, s23, 10
    s_add_u32 s40, s40, 151552
    v_add_u32 v10, s40, v2
    v_and_b32 v11, 0x7f, v7
    v_lshlrev_b32 v12, 3, v11
    v_add_u32 v13, 151552, v12
    v_lshlrev_b32 v11, 4, v11
    v_add_u32 v11, 155648, v11
    s_lshl_b32 s41, s21, 4
    s_add_u32 s42, s41, s22
    s_lshl_b32 s42, s42, 10
    s_add_u32 s42, s42, 262144
    s_lshl_b32 s43, s41, 10
    s_add_u32 s43, s43, 262144
    s_lshl_b32 s41, s41, 6
    s_add_u32 s44, s41, 49152
    s_lshl_b32 s47, s22, 6
    s_add_u32 s47, s47, s44
    s_lshr_b32 s41, s98, 1
    s_lshl_b32 s41, s41, 10
    s_add_u32 s41, s41, 32768
    v_lshrrev_b32 v17, 1, v1
    v_add_u32 v17, s30, v17
    v_subrev_u32 v18, 20, v17
    v_min_u32 v17, v17, v18
    v_lshlrev_b32 v17, 3, v17
    v_and_b32 v18, 1, v1
    v_add_u32 v17, v17, v18
    s_lshl_b32 s33, s23, 1
    v_add_u32 v17, s33, v17
    v_lshrrev_b32 v6, 2, v1
    v_lshlrev_b32 v17, 6, v17
    v_lshlrev_b32 v18, 6, v1
    v_and_b32 v16, 3, v1
    v_lshlrev_b32 v16, 2, v16
    v_add_u32 v16, s26, v16
    s_mov_b32 s45, 16384
    s_and_b32 s46, s22, 3
    v_lshrrev_b32 v21, 1, v1
    v_and_b32 v22, 1, v1
    v_mul_u32_u24 v50, 24, v21
    s_mul_i32 s33, s22, 3
    s_lshr_b32 s33, s33, 1
    v_add3_u32 v50, v50, v22, s33
    v_lshlrev_b32 v50, 6, v50
    v_mul_u32_u24 v51, 10, v21
    s_mul_i32 s33, s34, 5
    s_lshr_b32 s33, s33, 2
    v_add3_u32 v51, v51, v22, s33
    v_lshlrev_b32 v51, 6, v51
    s_mov_b32 s16, 81920
    s_mov_b32 s17, 65536
    s_lshl_b32 s36, s23, 2
    v_lshrrev_b32 v33, 2, v4
    v_add_u32 v33, s36, v33
    v_lshlrev_b32 v34, 1, v3
    v_xor_b32 v33, v33, v34
    v_lshlrev_b32 v33, 4, v33
    v_and_b32 v34, 3, v1
    v_lshl_add_u32 v33, v34, 2, v33
    v_lshl_add_u32 v33, v3, 8, v33
    s_and_b32 s33, s46, 1
    s_lshl_b32 s33, s33, 7
    v_xor_b32 v33, s33, v33
    s_lshl_b32 s33, s46, 11
    s_add_u32 s33, s33, 86016
    v_add_u32 v44, s33, v33
    v_xor_b32 v45, 128, v44
    s_lshl_b32 s36, s23, 8
    v_and_b32 v34, 1, v3
    v_lshrrev_b32 v33, 1, v3
    v_lshlrev_b32 v33, 2, v33
    v_lshl_add_u32 v33, v34, 3, v33
    v_lshl_add_u32 v33, v4, 4, v33
    v_add_u32 v46, s36, v33
    v_lshlrev_b32 v33, 10, v3
    v_lshl_add_u32 v33, v4, 4, v33
    v_add_u32 v47, s36, v33
    v_lshlrev_b32 v33, 1, v4
    v_lshrrev_b32 v34, 5, v1
    v_add_u32 v33, v33, v34
    s_lshl_b32 s36, s23, 5
    v_add_u32 v33, s36, v33
    v_lshlrev_b32 v33, 4, v33
    v_add_u32 v11, 155648, v33
    s_lshr_b32 s33, s23, 1
    s_mul_i32 s33, s33, 5
    s_add_u32 s33, s33, 0
    s_cmp_lt_u32 s33, 2
    s_cselect_b32 s48, 10240, 0
    s_cselect_b32 s53, 0, -4096
    s_cselect_b32 s36, 0, 83968
    s_add_u32 s48, s48, s36
    s_and_b32 s36, s23, 1
    s_mul_i32 s48, s48, s36
    s_mul_i32 s53, s53, s36
    s_add_u32 s53, s53, 12288
    s_lshl_b32 s33, s33, 10
    s_add_u32 s48, s48, s33
    s_lshr_b32 s33, s23, 1
    s_mul_i32 s33, s33, 5
    s_add_u32 s33, s33, 1
    s_cmp_lt_u32 s33, 2
    s_cselect_b32 s49, 10240, 0
    s_cselect_b32 s54, 0, -4096
    s_cselect_b32 s36, 0, 83968
    s_add_u32 s49, s49, s36
    s_and_b32 s36, s23, 1
    s_mul_i32 s49, s49, s36
    s_mul_i32 s54, s54, s36
    s_add_u32 s54, s54, 12288
    s_lshl_b32 s33, s33, 10
    s_add_u32 s49, s49, s33
    s_lshr_b32 s33, s23, 1
    s_mul_i32 s33, s33, 5
    s_add_u32 s33, s33, 2
    s_cmp_lt_u32 s33, 2
    s_cselect_b32 s50, 10240, 0
    s_cselect_b32 s55, 0, -4096
    s_cselect_b32 s36, 0, 83968
    s_add_u32 s50, s50, s36
    s_and_b32 s36, s23, 1
    s_mul_i32 s50, s50, s36
    s_mul_i32 s55, s55, s36
    s_add_u32 s55, s55, 12288
    s_lshl_b32 s33, s33, 10
    s_add_u32 s50, s50, s33
    s_lshr_b32 s33, s23, 1
    s_mul_i32 s33, s33, 5
    s_add_u32 s33, s33, 3
    s_cmp_lt_u32 s33, 2
    s_cselect_b32 s51, 10240, 0
    s_cselect_b32 s56, 0, -4096
    s_cselect_b32 s36, 0, 83968
    s_add_u32 s51, s51, s36
    s_and_b32 s36, s23, 1
    s_mul_i32 s51, s51, s36
    s_mul_i32 s56, s56, s36
    s_add_u32 s56, s56, 12288
    s_lshl_b32 s33, s33, 10
    s_add_u32 s51, s51, s33
    s_lshr_b32 s33, s23, 1
    s_mul_i32 s33, s33, 5
    s_add_u32 s33, s33, 4
    s_cmp_lt_u32 s33, 2
    s_cselect_b32 s52, 10240, 0
    s_cselect_b32 s57, 0, -4096
    s_cselect_b32 s36, 0, 83968
    s_add_u32 s52, s52, s36
    s_and_b32 s36, s23, 1
    s_mul_i32 s52, s52, s36
    s_mul_i32 s57, s57, s36
    s_add_u32 s57, s57, 12288
    s_lshl_b32 s33, s33, 10
    s_add_u32 s52, s52, s33
    s_cmp_lt_u32 s25, 20
    s_cbranch_scc1 L_isC_37
    v_mov_b32 v22, 158728
    s_mov_b32 s59, 2097152
L_lw_40:
    ds_read_b32 v23, v22
    s_waitcnt lgkmcnt(0)
    v_readfirstlane_b32 s58, v23
    s_nop 0
    s_cmp_ge_u32 s58, 4
    s_cbranch_scc1 L_lwok_41
    s_sleep 1
    s_sub_u32 s59, s59, 1
    s_cmp_lg_u32 s59, 0
    s_cbranch_scc1 L_lw_40
L_lwok_41:
    v_mov_b32 v22, 158764
    s_mov_b32 s59, 2097152
L_lw_42:
    ds_read_b32 v23, v22
    s_waitcnt lgkmcnt(0)
    v_readfirstlane_b32 s58, v23
    s_nop 0
    s_cmp_ge_u32 s58, 4
    s_cbranch_scc1 L_lwok_43
    s_sleep 1
    s_sub_u32 s59, s59, 1
    s_cmp_lg_u32 s59, 0
    s_cbranch_scc1 L_lw_42
L_lwok_43:
L_isC_37:
    s_cmp_lg_u32 s23, 0
    s_cbranch_scc1 L_nopoll_38
    s_mov_b32 exec_lo, 0xffff
    s_mov_b32 exec_hi, 0
    buffer_load_dword v22, v50, s[8:11], s16 offen sc1
    s_waitcnt vmcnt(0)
    s_mov_b32 exec_lo, 0xffff
    s_mov_b32 exec_hi, 0
    s_mov_b32 s59, 131072
L_poll_44:
    v_cmp_ne_u32 vcc, s18, v22
    s_nop 0
    s_and_b64 exec, exec, vcc
    s_cbranch_scc0 L_pollok_45
    s_sub_u32 s59, s59, 1
    s_cbranch_scc1 L_pollok_45
    buffer_load_dword v22, v50, s[8:11], s16 offen sc1
    s_waitcnt vmcnt(0)
    s_branch L_poll_44
L_pollok_45:
    s_mov_b64 exec, -1
    v_mov_b32 v22, 158756
    v_mov_b32 v23, 1
    s_mov_b64 exec, 1
    ds_add_u32 v22, v23
    s_mov_b64 exec, -1
    s_branch L_go_39
L_nopoll_38:
    v_mov_b32 v22, 158756
    s_mov_b32 s59, 2097152
L_lw_46:
    ds_read_b32 v23, v22
    s_waitcnt lgkmcnt(0)
    v_readfirstlane_b32 s58, v23
    s_nop 0
    s_cmp_ge_u32 s58, 1
    s_cbranch_scc1 L_lwok_47
    s_sleep 1
    s_sub_u32 s59, s59, 1
    s_cmp_lg_u32 s59, 0
    s_cbranch_scc1 L_lw_46
L_lwok_47:
L_go_39:
    s_mul_i32 s33, s31, 12288
    s_add_u32 m0, s27, 0
    s_add_u32 s33, s33, s28
    buffer_load_dwordx4 v2, s[8:11], s33 offen offset:0 sc1 lds
    buffer_load_dwordx4 v2, s[8:11], s33 offen offset:1024 sc1 lds
    buffer_load_dwordx4 v2, s[8:11], s33 offen offset:2048 sc1 lds
    s_add_u32 s31, s31, 1
    s_cmp_eq_u32 s31, 20
    s_cselect_b32 s31, 0, s31
    s_mul_i32 s33, s31, 12288
    s_add_u32 m0, s27, 12288
    s_add_u32 s33, s33, s28
    buffer_load_dwordx4 v2, s[8:11], s33 offen offset:0 sc1 lds
    buffer_load_dwordx4 v2, s[8:11], s33 offen offset:1024 sc1 lds
    buffer_load_dwordx4 v2, s[8:11], s33 offen offset:2048 sc1 lds
    s_add_u32 s31, s31, 1
    s_cmp_eq_u32 s31, 20
    s_cselect_b32 s31, 0, s31
    s_mul_i32 s33, s31, 12288
    s_add_u32 m0, s27, 24576
    s_add_u32 s33, s33, s28
    buffer_load_dwordx4 v2, s[8:11], s33 offen offset:0 sc1 lds
    buffer_load_dwordx4 v2, s[8:11], s33 offen offset:1024 sc1 lds
    buffer_load_dwordx4 v2, s[8:11], s33 offen offset:2048 sc1 lds
    s_add_u32 s31, s31, 1
    s_cmp_eq_u32 s31, 20
    s_cselect_b32 s31, 0, s31
    s_mul_i32 s33, s31, 12288
    s_add_u32 m0, s27, 36864
    s_add_u32 s33, s33, s28
    buffer_load_dwordx4 v2, s[8:11], s33 offen offset:0 sc1 lds
    buffer_load_dwordx4 v2, s[8:11], s33 offen offset:1024 sc1 lds
    buffer_load_dwordx4 v2, s[8:11], s33 offen offset:2048 sc1 lds
    s_add_u32 s31, s31, 1
    s_cmp_eq_u32 s31, 20
    s_cselect_b32 s31, 0, s31
    s_mul_i32 s33, s31, 12288
    s_add_u32 m0, s27, 49152
    s_add_u32 s33, s33, s28
    buffer_load_dwordx4 v2, s[8:11], s33 offen offset:0 sc1 lds
    buffer_load_dwordx4 v2, s[8:11], s33 offen offset:1024 sc1 lds
    buffer_load_dwordx4 v2, s[8:11], s33 offen offset:2048 sc1 lds
    s_add_u32 s31, s31, 1
    s_cmp_eq_u32 s31, 20
    s_cselect_b32 s31, 0, s31
    s_mul_i32 s33, s31, 12288
    s_add_u32 m0, s27, 61440
    s_add_u32 s33, s33, s28
    buffer_load_dwordx4 v2, s[8:11], s33 offen offset:0 sc1 lds
    buffer_load_dwordx4 v2, s[8:11], s33 offen offset:1024 sc1 lds
    buffer_load_dwordx4 v2, s[8:11], s33 offen offset:2048 sc1 lds
    s_add_u32 s31, s31, 1
    s_cmp_eq_u32 s31, 20
    s_cselect_b32 s31, 0, s31
    s_mul_i32 s33, s31, 12288
    s_add_u32 m0, s27, 73728
    s_add_u32 s33, s33, s28
    buffer_load_dwordx4 v2, s[8:11], s33 offen offset:0 sc1 lds
    buffer_load_dwordx4 v2, s[8:11], s33 offen offset:1024 sc1 lds
    buffer_load_dwordx4 v2, s[8:11], s33 offen offset:2048 sc1 lds
    s_add_u32 s31, s31, 1
    s_cmp_eq_u32 s31, 20
    s_cselect_b32 s31, 0, s31
    buffer_load_dword v52, v8, s[8:11], s39 offen sc1
    s_add_u32 s39, s39, 12288
    buffer_load_dword v53, v8, s[8:11], s39 offen sc1
    s_add_u32 s39, s39, 12288
    buffer_load_dword v54, v8, s[8:11], s39 offen sc1
    s_add_u32 s39, s39, 12288
    buffer_load_dword v55, v8, s[8:11], s39 offen sc1
    s_waitcnt vmcnt(0)
    v_add_f32 v52, v52, v53
    v_add_f32 v54, v54, v55
    v_add_f32 v52, v52, v54
    v_mov_b32 v22, 158760
    s_mov_b32 s59, 2097152
L_lw_48:
    ds_read_b32 v23, v22
    s_waitcnt lgkmcnt(0)
    v_readfirstlane_b32 s58, v23
    s_nop 0
    s_cmp_ge_u32 s58, 4
    s_cbranch_scc1 L_lwok_49
    s_sleep 1
    s_sub_u32 s59, s59, 1
    s_cmp_lg_u32 s59, 0
    s_cbranch_scc1 L_lw_48
L_lwok_49:
    ds_write_b32 v9, v52
    s_mov_b32 exec_lo, 0xff
    s_mov_b32 exec_hi, 0
    buffer_load_dword v22, v17, s[8:11], s45 offen sc1
    s_waitcnt vmcnt(0)
    s_mov_b32 exec_lo, 0xff
    s_mov_b32 exec_hi, 0
    s_mov_b32 s59, 131072
L_poll_50:
    v_cmp_ne_u32 vcc, s18, v22
    s_nop 0
    s_and_b64 exec, exec, vcc
    s_cbranch_scc0 L_pollok_51
    s_sub_u32 s59, s59, 1
    s_cbranch_scc1 L_pollok_51
    buffer_load_dword v22, v17, s[8:11], s45 offen sc1
    s_waitcnt vmcnt(0)
    s_branch L_poll_50
L_pollok_51:
    s_mov_b64 exec, -1
    s_lshl_b32 s33, s32, 17
    s_add_u32 m0, s26, 0
    s_add_u32 s33, s33, s29
    buffer_load_dwordx4 v5, s[8:11], s33 offen sc1 lds
    s_add_u32 m0, s26, 1024
    s_add_u32 s33, s33, 16384
    buffer_load_dwordx4 v5, s[8:11], s33 offen sc1 lds
    s_add_u32 s32, s32, 1
    s_cmp_eq_u32 s32, 20
    s_cselect_b32 s32, 0, s32
    s_mov_b32 exec_lo, 0xffffff00
    s_mov_b32 exec_hi, 0xff
    buffer_load_dword v22, v17, s[8:11], s45 offen sc1
    s_mov_b64 exec, -1
    s_lshl_b32 s33, s32, 17
    s_add_u32 m0, s26, 8192
    s_add_u32 s33, s33, s29
    buffer_load_dwordx4 v5, s[8:11], s33 offen sc1 lds
    s_add_u32 m0, s26, 9216
    s_add_u32 s33, s33, 16384
    buffer_load_dwordx4 v5, s[8:11], s33 offen sc1 lds
    s_add_u32 s32, s32, 1
    s_cmp_eq_u32 s32, 20
    s_cselect_b32 s32, 0, s32
    s_lshl_b32 s33, s32, 17
    s_add_u32 m0, s26, 16384
    s_add_u32 s33, s33, s29
    buffer_load_dwordx4 v5, s[8:11], s33 offen sc1 lds
    s_add_u32 m0, s26, 17408
    s_add_u32 s33, s33, 16384
    buffer_load_dwordx4 v5, s[8:11], s33 offen sc1 lds
    s_add_u32 s32, s32, 1
    s_cmp_eq_u32 s32, 20
    s_cselect_b32 s32, 0, s32
    s_lshl_b32 s33, s32, 17
    s_add_u32 m0, s26, 24576
    s_add_u32 s33, s33, s29
    buffer_load_dwordx4 v5, s[8:11], s33 offen sc1 lds
    s_add_u32 m0, s26, 25600
    s_add_u32 s33, s33, 16384
    buffer_load_dwordx4 v5, s[8:11], s33 offen sc1 lds
    s_add_u32 s32, s32, 1
    s_cmp_eq_u32 s32, 20
    s_cselect_b32 s32, 0, s32
    s_waitcnt vmcnt(4)
    s_waitcnt lgkmcnt(0)
    s_barrier
    ds_read_b32 v24, v44 offset:0
    ds_read_b32 v25, v44 offset:1024
    ds_read_b32 v26, v45 offset:2048
    ds_read_b32 v27, v45 offset:3072
    ds_read_b32 v28, v44 offset:4096
    ds_read_b32 v29, v44 offset:5120
    ds_read_b32 v30, v45 offset:6144
    ds_read_b32 v31, v45 offset:7168
    ds_read_b32 v32, v44 offset:8192
    ds_read_b32 v33, v44 offset:9216
    s_mov_b32 exec_lo, 0xffffff00
    s_mov_b32 exec_hi, 0xff
    s_mov_b32 s59, 131072
L_poll_52:
    v_cmp_ne_u32 vcc, s18, v22
    s_nop 0
    s_and_b64 exec, exec, vcc
    s_cbranch_scc0 L_pollok_53
    s_sub_u32 s59, s59, 1
    s_cbranch_scc1 L_pollok_53
    buffer_load_dword v22, v17, s[8:11], s45 offen sc1
    s_waitcnt vmcnt(0)
    s_branch L_poll_52
L_pollok_53:
    s_mov_b64 exec, -1
    s_lshl_b32 s33, s32, 17
    s_add_u32 m0, s26, 32768
    s_add_u32 s33, s33, s29
    buffer_load_dwordx4 v5, s[8:11], s33 offen sc1 lds
    s_add_u32 m0, s26, 33792
    s_add_u32 s33, s33, 16384
    buffer_load_dwordx4 v5, s[8:11], s33 offen sc1 lds
    s_add_u32 s32, s32, 1
    s_cmp_eq_u32 s32, 20
    s_cselect_b32 s32, 0, s32
    s_lshl_b32 s33, s32, 17
    s_add_u32 m0, s26, 40960
    s_add_u32 s33, s33, s29
    buffer_load_dwordx4 v5, s[8:11], s33 offen sc1 lds
    s_add_u32 m0, s26, 41984
    s_add_u32 s33, s33, 16384
    buffer_load_dwordx4 v5, s[8:11], s33 offen sc1 lds
    s_add_u32 s32, s32, 1
    s_cmp_eq_u32 s32, 20
    s_cselect_b32 s32, 0, s32
    s_waitcnt lgkmcnt(0)
    s_barrier
    s_cmp_lg_u32 s23, 0
    s_cbranch_scc1 L_w4only_54
    s_cmp_lg_u32 s2, 0
    s_cbranch_scc1 L_nonw_55
    s_mov_b32 s33, 0
    v_mov_b32 v22, 0
    v_mov_b32 v23, s18
    s_mov_b64 exec, 1
    buffer_store_dword v23, v22, s[8:11], s33 offen sc1
    s_mov_b64 exec, -1
L_nonw_55:
L_w4only_54:
    s_mul_i32 s33, s31, 12288
    s_add_u32 m0, s27, 0
    s_add_u32 s33, s33, s28
    buffer_load_dwordx4 v2, s[8:11], s33 offen offset:0 sc1 lds
    v_lshlrev_b32 v40, 16, v24
    v_and_b32 v42, 0xffff0000, v24
    v_mul_f32 v41, v40, v40
    v_mul_f32 v43, v42, v42
    v_lshlrev_b32 v48, 16, v25
    buffer_load_dwordx4 v2, s[8:11], s33 offen offset:1024 sc1 lds
    v_and_b32 v49, 0xffff0000, v25
    v_add_f32 v40, v40, v48
    v_add_f32 v42, v42, v49
    v_fmac_f32 v41, v48, v48
    v_fmac_f32 v43, v49, v49
    buffer_load_dwordx4 v2, s[8:11], s33 offen offset:2048 sc1 lds
    v_lshlrev_b32 v48, 16, v26
    v_and_b32 v49, 0xffff0000, v26
    v_add_f32 v40, v40, v48
    v_add_f32 v42, v42, v49
    v_fmac_f32 v41, v48, v48
    s_add_u32 s31, s31, 1
    s_cmp_eq_u32 s31, 20
    s_cselect_b32 s31, 0, s31
    s_lshl_b32 s33, s32, 17
    s_add_u32 m0, s26, 49152
    s_add_u32 s33, s33, s29
    buffer_load_dwordx4 v5, s[8:11], s33 offen sc1 lds
    v_fmac_f32 v43, v49, v49
    v_lshlrev_b32 v48, 16, v27
    v_and_b32 v49, 0xffff0000, v27
    v_add_f32 v40, v40, v48
    v_add_f32 v42, v42, v49
    s_add_u32 m0, s26, 50176
    s_add_u32 s33, s33, 16384
    buffer_load_dwordx4 v5, s[8:11], s33 offen sc1 lds
    v_fmac_f32 v41, v48, v48
    v_fmac_f32 v43, v49, v49
    s_add_u32 s32, s32, 1
    s_cmp_eq_u32 s32, 20
    s_cselect_b32 s32, 0, s32
    s_waitcnt vmcnt(11)
    s_barrier
    s_mul_i32 s33, s31, 12288
    s_add_u32 m0, s27, 12288
    s_add_u32 s33, s33, s28
    buffer_load_dwordx4 v2, s[8:11], s33 offen offset:0 sc1 lds
    v_lshlrev_b32 v48, 16, v28
    v_and_b32 v49, 0xffff0000, v28
    v_add_f32 v40, v40, v48
    v_add_f32 v42, v42, v49
    buffer_load_dwordx4 v2, s[8:11], s33 offen offset:1024 sc1 lds
    v_fmac_f32 v41, v48, v48
    v_fmac_f32 v43, v49, v49
    v_lshlrev_b32 v48, 16, v29
    v_and_b32 v49, 0xffff0000, v29
    buffer_load_dwordx4 v2, s[8:11], s33 offen offset:2048 sc1 lds
    v_add_f32 v40, v40, v48
    v_add_f32 v42, v42, v49
    v_fmac_f32 v41, v48, v48
    v_fmac_f32 v43, v49, v49
    s_add_u32 s31, s31, 1
    s_cmp_eq_u32 s31, 20
    s_cselect_b32 s31, 0, s31
    s_lshl_b32 s33, s32, 17
    s_add_u32 m0, s26, 0
    s_add_u32 s33, s33, s29
    buffer_load_dwordx4 v5, s[8:11], s33 offen sc1 lds
    v_lshlrev_b32 v48, 16, v30
    v_and_b32 v49, 0xffff0000, v30
    v_add_f32 v40, v40, v48
    v_add_f32 v42, v42, v49
    s_add_u32 m0, s26, 1024
    s_add_u32 s33, s33, 16384
    buffer_load_dwordx4 v5, s[8:11], s33 offen sc1 lds
    v_fmac_f32 v41, v48, v48
    v_fmac_f32 v43, v49, v49
    s_add_u32 s32, s32, 1
    s_cmp_eq_u32 s32, 20
    s_cselect_b32 s32, 0, s32
    s_waitcnt vmcnt(14)
    s_barrier
    s_mul_i32 s33, s31, 12288
    s_add_u32 m0, s27, 24576
    s_add_u32 s33, s33, s28
    buffer_load_dwordx4 v2, s[8:11], s33 offen offset:0 sc1 lds
    v_lshlrev_b32 v48, 16, v31
    v_and_b32 v49, 0xffff0000, v31
    v_add_f32 v40, v40, v48
    v_add_f32 v42, v42, v49
    buffer_load_dwordx4 v2, s[8:11], s33 offen offset:1024 sc1 lds
    v_fmac_f32 v41, v48, v48
    v_fmac_f32 v43, v49, v49
    v_lshlrev_b32 v48, 16, v32
    v_and_b32 v49, 0xffff0000, v32
    buffer_load_dwordx4 v2, s[8:11], s33 offen offset:2048 sc1 lds
    v_add_f32 v40, v40, v48
    v_add_f32 v42, v42, v49
    v_fmac_f32 v41, v48, v48
    v_fmac_f32 v43, v49, v49
    s_add_u32 s31, s31, 1
    s_cmp_eq_u32 s31, 20
    s_cselect_b32 s31, 0, s31
    s_lshl_b32 s33, s32, 17
    s_add_u32 m0, s26, 8192
    s_add_u32 s33, s33, s29
    buffer_load_dwordx4 v5, s[8:11], s33 offen sc1 lds
    v_lshlrev_b32 v48, 16, v33
    v_and_b32 v49, 0xffff0000, v33
    v_add_f32 v40, v40, v48
    v_add_f32 v42, v42, v49
    s_add_u32 m0, s26, 9216
    s_add_u32 s33, s33, 16384
    buffer_load_dwordx4 v5, s[8:11], s33 offen sc1 lds
    v_fmac_f32 v41, v48, v48
    v_fmac_f32 v43, v49, v49
    s_add_u32 s32, s32, 1
    s_cmp_eq_u32 s32, 20
    s_cselect_b32 s32, 0, s32
    s_waitcnt vmcnt(17)
    s_barrier
    s_mul_i32 s33, s31, 12288
    s_add_u32 m0, s27, 36864
    s_add_u32 s33, s33, s28
    buffer_load_dwordx4 v2, s[8:11], s33 offen offset:0 sc1 lds
    v_permlane32_swap_b32 v40, v41
    v_add_f32 v40, v40, v41
    buffer_load_dwordx4 v2, s[8:11], s33 offen offset:1024 sc1 lds
    v_permlane32_swap_b32 v42, v43
    v_add_f32 v42, v42, v43
    buffer_load_dwordx4 v2, s[8:11], s33 offen offset:2048 sc1 lds
    s_nop 0
    v_permlane16_swap_b32 v40, v42
    v_add_f32 v40, v40, v42
    s_add_u32 s31, s31, 1
    s_cmp_eq_u32 s31, 20
    s_cselect_b32 s31, 0, s31
    s_lshl_b32 s33, s32, 17
    s_add_u32 m0, s26, 16384
    s_add_u32 s33, s33, s29
    buffer_load_dwordx4 v5, s[8:11], s33 offen sc1 lds
    s_add_u32 m0, s26, 17408
    s_add_u32 s33, s33, 16384
    buffer_load_dwordx4 v5, s[8:11], s33 offen sc1 lds
    s_add_u32 s32, s32, 1
    s_cmp_eq_u32 s32, 20
    s_cselect_b32 s32, 0, s32
    buffer_store_dword v40, v46, s[8:11], s42 offen sc1
    s_waitcnt vmcnt(21)
    s_barrier
    s_mul_i32 s33, s31, 12288
    s_add_u32 m0, s27, 49152
    s_add_u32 s33, s33, s28
    buffer_load_dwordx4 v2, s[8:11], s33 offen offset:0 sc1 lds
    buffer_load_dwordx4 v2, s[8:11], s33 offen offset:1024 sc1 lds
    buffer_load_dwordx4 v2, s[8:11], s33 offen offset:2048 sc1 lds
    s_add_u32 s31, s31, 1
    s_cmp_eq_u32 s31, 20
    s_cselect_b32 s31, 0, s31
    s_lshl_b32 s33, s32, 17
    s_add_u32 m0, s26, 24576
    s_add_u32 s33, s33, s29
    buffer_load_dwordx4 v5, s[8:11], s33 offen sc1 lds
    s_add_u32 m0, s26, 25600
    s_add_u32 s33, s33, 16384
    buffer_load_dwordx4 v5, s[8:11], s33 offen sc1 lds
    s_add_u32 s32, s32, 1
    s_cmp_eq_u32 s32, 20
    s_cselect_b32 s32, 0, s32
    s_waitcnt vmcnt(21)
    s_barrier
    s_mul_i32 s33, s31, 12288
    s_add_u32 m0, s27, 61440
    s_add_u32 s33, s33, s28
    buffer_load_dwordx4 v2, s[8:11], s33 offen offset:0 sc1 lds
    buffer_load_dwordx4 v2, s[8:11], s33 offen offset:1024 sc1 lds
    buffer_load_dwordx4 v2, s[8:11], s33 offen offset:2048 sc1 lds
    s_add_u32 s31, s31, 1
    s_cmp_eq_u32 s31, 20
    s_cselect_b32 s31, 0, s31
    s_lshl_b32 s33, s32, 17
    s_add_u32 m0, s26, 32768
    s_add_u32 s33, s33, s29
    buffer_load_dwordx4 v5, s[8:11], s33 offen sc1 lds
    s_add_u32 m0, s26, 33792
    s_add_u32 s33, s33, 16384
    buffer_load_dwordx4 v5, s[8:11], s33 offen sc1 lds
    s_add_u32 s32, s32, 1
    s_cmp_eq_u32 s32, 20
    s_cselect_b32 s32, 0, s32
    s_waitcnt vmcnt(10)
    s_barrier
    s_cmp_lg_u32 s23, 0
    s_cbranch_scc1 L_w4only_56
    v_mov_b32 v22, 0
    v_mov_b32 v23, s18
    s_mov_b64 exec, 1
    buffer_store_dword v23, v22, s[8:11], s47 offen sc1
    s_mov_b64 exec, -1
L_w4only_56:
    s_mul_i32 s33, s31, 12288
    s_add_u32 m0, s27, 73728
    s_add_u32 s33, s33, s28
    buffer_load_dwordx4 v2, s[8:11], s33 offen offset:0 sc1 lds
    buffer_load_dwordx4 v2, s[8:11], s33 offen offset:1024 sc1 lds
    buffer_load_dwordx4 v2, s[8:11], s33 offen offset:2048 sc1 lds
    s_add_u32 s31, s31, 1
    s_cmp_eq_u32 s31, 20
    s_cselect_b32 s31, 0, s31
    s_lshl_b32 s33, s32, 17
    s_add_u32 m0, s26, 40960
    s_add_u32 s33, s33, s29
    buffer_load_dwordx4 v5, s[8:11], s33 offen sc1 lds
    s_add_u32 m0, s26, 41984
    s_add_u32 s33, s33, 16384
    buffer_load_dwordx4 v5, s[8:11], s33 offen sc1 lds
    s_add_u32 s32, s32, 1
    s_cmp_eq_u32 s32, 20
    s_cselect_b32 s32, 0, s32
    s_barrier
    s_mul_i32 s33, s31, 12288
    s_add_u32 m0, s27, 0
    s_add_u32 s33, s33, s28
    buffer_load_dwordx4 v2, s[8:11], s33 offen offset:0 sc1 lds
    buffer_load_dwordx4 v2, s[8:11], s33 offen offset:1024 sc1 lds
    buffer_load_dwordx4 v2, s[8:11], s33 offen offset:2048 sc1 lds
    s_add_u32 s31, s31, 1
    s_cmp_eq_u32 s31, 20
    s_cselect_b32 s31, 0, s31
    s_lshl_b32 s33, s32, 17
    s_add_u32 m0, s26, 49152
    s_add_u32 s33, s33, s29
    buffer_load_dwordx4 v5, s[8:11], s33 offen sc1 lds
    s_add_u32 m0, s26, 50176
    s_add_u32 s33, s33, 16384
    buffer_load_dwordx4 v5, s[8:11], s33 offen sc1 lds
    s_add_u32 s32, s32, 1
    s_cmp_eq_u32 s32, 20
    s_cselect_b32 s32, 0, s32
    s_barrier
    s_mul_i32 s33, s31, 12288
    s_add_u32 m0, s27, 12288
    s_add_u32 s33, s33, s28
    buffer_load_dwordx4 v2, s[8:11], s33 offen offset:0 sc1 lds
    buffer_load_dwordx4 v2, s[8:11], s33 offen offset:1024 sc1 lds
    buffer_load_dwordx4 v2, s[8:11], s33 offen offset:2048 sc1 lds
    s_add_u32 s31, s31, 1
    s_cmp_eq_u32 s31, 20
    s_cselect_b32 s31, 0, s31
    s_lshl_b32 s33, s32, 17
    s_add_u32 m0, s26, 0
    s_add_u32 s33, s33, s29
    buffer_load_dwordx4 v5, s[8:11], s33 offen sc1 lds
    s_add_u32 m0, s26, 1024
    s_add_u32 s33, s33, 16384
    buffer_load_dwordx4 v5, s[8:11], s33 offen sc1 lds
    s_add_u32 s32, s32, 1
    s_cmp_eq_u32 s32, 20
    s_cselect_b32 s32, 0, s32
    s_waitcnt vmcnt(20)
    s_barrier
    s_mul_i32 s33, s31, 12288
    s_add_u32 m0, s27, 24576
    s_add_u32 s33, s33, s28
    buffer_load_dwordx4 v2, s[8:11], s33 offen offset:0 sc1 lds
    buffer_load_dwordx4 v2, s[8:11], s33 offen offset:1024 sc1 lds
    buffer_load_dwordx4 v2, s[8:11], s33 offen offset:2048 sc1 lds
    s_add_u32 s31, s31, 1
    s_cmp_eq_u32 s31, 20
    s_cselect_b32 s31, 0, s31
    s_lshl_b32 s33, s32, 17
    s_add_u32 m0, s26, 8192
    s_add_u32 s33, s33, s29
    buffer_load_dwordx4 v5, s[8:11], s33 offen sc1 lds
    s_add_u32 m0, s26, 9216
    s_add_u32 s33, s33, 16384
    buffer_load_dwordx4 v5, s[8:11], s33 offen sc1 lds
    s_add_u32 s32, s32, 1
    s_cmp_eq_u32 s32, 20
    s_cselect_b32 s32, 0, s32
    s_waitcnt vmcnt(20)
    s_barrier
    s_mul_i32 s33, s31, 12288
    s_add_u32 m0, s27, 36864
    s_add_u32 s33, s33, s28
    buffer_load_dwordx4 v2, s[8:11], s33 offen offset:0 sc1 lds
    buffer_load_dwordx4 v2, s[8:11], s33 offen offset:1024 sc1 lds
    buffer_load_dwordx4 v2, s[8:11], s33 offen offset:2048 sc1 lds
    s_add_u32 s31, s31, 1
    s_cmp_eq_u32 s31, 20
    s_cselect_b32 s31, 0, s31
    s_lshl_b32 s33, s32, 17
    s_add_u32 m0, s26, 16384
    s_add_u32 s33, s33, s29
    buffer_load_dwordx4 v5, s[8:11], s33 offen sc1 lds
    s_add_u32 m0, s26, 17408
    s_add_u32 s33, s33, 16384
    buffer_load_dwordx4 v5, s[8:11], s33 offen sc1 lds
    s_add_u32 s32, s32, 1
    s_cmp_eq_u32 s32, 20
    s_cselect_b32 s32, 0, s32
    s_waitcnt vmcnt(20)
    s_barrier
    s_mov_b32 exec_lo, 0xffff
    s_mov_b32 exec_hi, 0
    buffer_load_dword v22, v18, s[8:11], s44 offen sc1
    buffer_load_dword v23, v51, s[8:11], s17 offen sc1
    s_mov_b64 exec, -1
    s_mul_i32 s33, s31, 12288
    s_add_u32 m0, s27, 49152
    s_add_u32 s33, s33, s28
    buffer_load_dwordx4 v2, s[8:11], s33 offen offset:0 sc1 lds
    buffer_load_dwordx4 v2, s[8:11], s33 offen offset:1024 sc1 lds
    buffer_load_dwordx4 v2, s[8:11], s33 offen offset:2048 sc1 lds
    s_add_u32 s31, s31, 1
    s_cmp_eq_u32 s31, 20
    s_cselect_b32 s31, 0, s31
    s_lshl_b32 s33, s32, 17
    s_add_u32 m0, s26, 24576
    s_add_u32 s33, s33, s29
    buffer_load_dwordx4 v5, s[8:11], s33 offen sc1 lds
    s_add_u32 m0, s26, 25600
    s_add_u32 s33, s33, 16384
    buffer_load_dwordx4 v5, s[8:11], s33 offen sc1 lds
    s_add_u32 s32, s32, 1
    s_cmp_eq_u32 s32, 20
    s_cselect_b32 s32, 0, s32
    s_waitcnt vmcnt(22)
    s_barrier
    s_waitcnt vmcnt(5)
    s_mov_b32 exec_lo, 0xffff
    s_mov_b32 exec_hi, 0
    s_mov_b32 s59, 131072
L_poll_57:
    v_cmp_ne_u32 vcc, s18, v22
    s_nop 0
    s_and_b64 exec, exec, vcc
    s_cbranch_scc0 L_pollok_58
    s_sub_u32 s59, s59, 1
    s_cbranch_scc1 L_pollok_58
    buffer_load_dword v22, v18, s[8:11], s44 offen sc1
    s_waitcnt vmcnt(0)
    s_branch L_poll_57
L_pollok_58:
    s_mov_b64 exec, -1
    s_mov_b32 exec_lo, 0xffff
    s_mov_b32 exec_hi, 0
    s_mov_b32 s59, 131072
L_poll_59:
    v_cmp_ne_u32 vcc, s18, v23
    s_nop 0
    s_and_b64 exec, exec, vcc
    s_cbranch_scc0 L_pollok_60
    s_sub_u32 s59, s59, 1
    s_cbranch_scc1 L_pollok_60
    buffer_load_dword v23, v51, s[8:11], s17 offen sc1
    s_waitcnt vmcnt(0)
    s_branch L_poll_59
L_pollok_60:
    s_mov_b64 exec, -1
    buffer_load_dwordx4 v[64:67], v47, s[8:11], s43 offen sc1
    s_add_u32 s43, s43, 4096
    buffer_load_dwordx4 v[68:71], v47, s[8:11], s43 offen sc1
    s_add_u32 s43, s43, 4096
    buffer_load_dwordx4 v[72:75], v47, s[8:11], s43 offen sc1
    s_add_u32 s43, s43, 4096
    buffer_load_dwordx4 v[76:79], v47, s[8:11], s43 offen sc1
    s_mul_i32 s33, s31, 12288
    s_add_u32 m0, s27, 61440
    s_add_u32 s33, s33, s28
    buffer_load_dwordx4 v2, s[8:11], s33 offen offset:0 sc1 lds
    buffer_load_dwordx4 v2, s[8:11], s33 offen offset:1024 sc1 lds
    buffer_load_dwordx4 v2, s[8:11], s33 offen offset:2048 sc1 lds
    s_add_u32 s31, s31, 1
    s_cmp_eq_u32 s31, 20
    s_cselect_b32 s31, 0, s31
    s_lshl_b32 s33, s32, 17
    s_add_u32 m0, s26, 32768
    s_add_u32 s33, s33, s29
    buffer_load_dwordx4 v5, s[8:11], s33 offen sc1 lds
    s_add_u32 m0, s26, 33792
    s_add_u32 s33, s33, 16384
    buffer_load_dwordx4 v5, s[8:11], s33 offen sc1 lds
    s_add_u32 s32, s32, 1
    s_cmp_eq_u32 s32, 20
    s_cselect_b32 s32, 0, s32
    s_barrier
    s_lshl_b32 s33, s32, 17
    s_add_u32 m0, s26, 40960
    s_add_u32 s33, s33, s29
    buffer_load_dwordx4 v5, s[8:11], s33 offen sc1 lds
    s_add_u32 m0, s26, 41984
    s_add_u32 s33, s33, 16384
    buffer_load_dwordx4 v5, s[8:11], s33 offen sc1 lds
    s_add_u32 s32, s32, 1
    s_cmp_eq_u32 s32, 20
    s_cselect_b32 s32, 0, s32
    s_barrier
    s_waitcnt vmcnt(7)
    s_mul_i32 s33, s53, 6
    s_add_u32 m0, s33, s48
    s_add_u32 s33, s35, 0
    buffer_load_dwordx4 v2, s[8:11], s33 offen sc1 lds
    v_add_f32 v64, v64, v68
    v_add_f32 v65, v65, v69
    v_add_f32 v66, v66, v70
    s_mul_i32 s33, s54, 6
    s_add_u32 m0, s33, s49
    s_add_u32 s33, s35, 1024
    buffer_load_dwordx4 v2, s[8:11], s33 offen sc1 lds
    v_add_f32 v67, v67, v71
    v_add_f32 v72, v72, v76
    v_add_f32 v73, v73, v77
    s_mul_i32 s33, s55, 6
    s_add_u32 m0, s33, s50
    s_add_u32 s33, s35, 2048
    buffer_load_dwordx4 v2, s[8:11], s33 offen sc1 lds
    v_add_f32 v74, v74, v78
    v_add_f32 v75, v75, v79
    v_add_f32 v64, v64, v72
    s_mul_i32 s33, s56, 6
    s_add_u32 m0, s33, s51
    s_add_u32 s33, s35, 3072
    buffer_load_dwordx4 v2, s[8:11], s33 offen sc1 lds
    v_add_f32 v65, v65, v73
    v_add_f32 v66, v66, v74
    v_add_f32 v67, v67, v75
    s_mul_i32 s33, s57, 6
    s_add_u32 m0, s33, s52
    s_add_u32 s33, s35, 4096
    buffer_load_dwordx4 v2, s[8:11], s33 offen sc1 lds
    s_add_u32 s35, s35, 20480
    s_barrier
    s_mul_i32 s33, s53, 0
    s_add_u32 m0, s33, s48
    s_add_u32 s33, s35, 0
    buffer_load_dwordx4 v2, s[8:11], s33 offen sc1 lds
    v_permlane32_swap_b32 v64, v66
    v_add_f32 v64, v64, v66
    v_permlane32_swap_b32 v65, v67
    v_add_f32 v65, v65, v67
    s_mul_i32 s33, s54, 0
    s_add_u32 m0, s33, s49
    s_add_u32 s33, s35, 1024
    buffer_load_dwordx4 v2, s[8:11], s33 offen sc1 lds
    v_mov_b32 v66, v64
    v_mov_b32 v67, v65
    s_nop 0
    v_permlane16_swap_b32 v64, v66
    v_add_f32 v64, v64, v66
    s_mul_i32 s33, s55, 0
    s_add_u32 m0, s33, s50
    s_add_u32 s33, s35, 2048
    buffer_load_dwordx4 v2, s[8:11], s33 offen sc1 lds
    v_permlane16_swap_b32 v65, v67
    v_add_f32 v65, v65, v67
    v_mul_f32 v64, 0x3acccccd, v64
    v_mul_f32 v65, 0x3acccccd, v65
    s_mul_i32 s33, s56, 0
    s_add_u32 m0, s33, s51
    s_add_u32 s33, s35, 3072
    buffer_load_dwordx4 v2, s[8:11], s33 offen sc1 lds
    v_fma_f32 v65, -v64, v64, v65
    v_max_f32 v65, 0, v65
    v_cvt_pk_bf16_f32 v64, v64, v65
    v_and_b32 v65, 0xffff0000, v64
    s_mul_i32 s33, s57, 0
    s_add_u32 m0, s33, s52
    s_add_u32 s33, s35, 4096
    buffer_load_dwordx4 v2, s[8:11], s33 offen sc1 lds
    v_lshlrev_b32 v64, 16, v64
    v_add_f32 v65, 0x3727c5ac, v65
    s_add_u32 s35, s35, 20480
    s_barrier
    s_mul_i32 s33, s53, 1
    s_add_u32 m0, s33, s48
    s_add_u32 s33, s35, 0
    buffer_load_dwordx4 v2, s[8:11], s33 offen sc1 lds
    v_cvt_pk_bf16_f32 v65, v65, v65
    v_lshlrev_b32 v65, 16, v65
    v_sqrt_f32 v65, v65
    s_mul_i32 s33, s54, 1
    s_add_u32 m0, s33, s49
    s_add_u32 s33, s35, 1024
    buffer_load_dwordx4 v2, s[8:11], s33 offen sc1 lds
    s_nop 0
    v_cvt_pk_bf16_f32 v65, v65, v65
    v_lshlrev_b32 v65, 16, v65
    s_mul_i32 s33, s55, 1
    s_add_u32 m0, s33, s50
    s_add_u32 s33, s35, 2048
    buffer_load_dwordx4 v2, s[8:11], s33 offen sc1 lds
    v_rcp_f32 v28, v65
    v_mul_f32 v29, v65, v65
    v_sub_f32 v30, 0, v64
    s_mul_i32 s33, s56, 1
    s_add_u32 m0, s33, s51
    s_add_u32 s33, s35, 3072
    buffer_load_dwordx4 v2, s[8:11], s33 offen sc1 lds
    v_mul_f32 v28, 0xbfb8aa3b, v28
    v_mov_b32 v31, 0
    s_mul_i32 s33, s57, 1
    s_add_u32 m0, s33, s52
    s_add_u32 s33, s35, 4096
    buffer_load_dwordx4 v2, s[8:11], s33 offen sc1 lds
    s_add_u32 s35, s35, 20480
    s_waitcnt vmcnt(17)
    ds_write_b128 v11, v[28:31]
    s_barrier
    s_mul_i32 s33, s53, 2
    s_add_u32 m0, s33, s48
    s_add_u32 s33, s35, 0
    buffer_load_dwordx4 v2, s[8:11], s33 offen sc1 lds
    s_mul_i32 s33, s54, 2
    s_add_u32 m0, s33, s49
    s_add_u32 s33, s35, 1024
    buffer_load_dwordx4 v2, s[8:11], s33 offen sc1 lds
    s_mul_i32 s33, s55, 2
    s_add_u32 m0, s33, s50
    s_add_u32 s33, s35, 2048
    buffer_load_dwordx4 v2, s[8:11], s33 offen sc1 lds
    s_mul_i32 s33, s56, 2
    s_add_u32 m0, s33, s51
    s_add_u32 s33, s35, 3072
    buffer_load_dwordx4 v2, s[8:11], s33 offen sc1 lds
    s_mul_i32 s33, s57, 2
    s_add_u32 m0, s33, s52
    s_add_u32 s33, s35, 4096
    buffer_load_dwordx4 v2, s[8:11], s33 offen sc1 lds
    s_add_u32 s35, s35, 20480
    s_waitcnt vmcnt(20)
    s_waitcnt lgkmcnt(0)
    s_barrier
    s_mul_i32 s33, s53, 3
    s_add_u32 m0, s33, s48
    s_add_u32 s33, s35, 0
    buffer_load_dwordx4 v2, s[8:11], s33 offen sc1 lds
    s_mul_i32 s33, s54, 3
    s_add_u32 m0, s33, s49
    s_add_u32 s33, s35, 1024
    buffer_load_dwordx4 v2, s[8:11], s33 offen sc1 lds
    s_mul_i32 s33, s55, 3
    s_add_u32 m0, s33, s50
    s_add_u32 s33, s35, 2048
    buffer_load_dwordx4 v2, s[8:11], s33 offen sc1 lds
    s_mul_i32 s33, s56, 3
    s_add_u32 m0, s33, s51
    s_add_u32 s33, s35, 3072
    buffer_load_dwordx4 v2, s[8:11], s33 offen sc1 lds
    s_mul_i32 s33, s57, 3
    s_add_u32 m0, s33, s52
    s_add_u32 s33, s35, 4096
    buffer_load_dwordx4 v2, s[8:11], s33 offen sc1 lds
    s_add_u32 s35, s35, 20480
    s_barrier
    s_mul_i32 s33, s53, 4
    s_add_u32 m0, s33, s48
    s_add_u32 s33, s35, 0
    buffer_load_dwordx4 v2, s[8:11], s33 offen sc1 lds
    s_mul_i32 s33, s54, 4
    s_add_u32 m0, s33, s49
    s_add_u32 s33, s35, 1024
    buffer_load_dwordx4 v2, s[8:11], s33 offen sc1 lds
    s_mul_i32 s33, s55, 4
    s_add_u32 m0, s33, s50
    s_add_u32 s33, s35, 2048
    buffer_load_dwordx4 v2, s[8:11], s33 offen sc1 lds
    s_mul_i32 s33, s56, 4
    s_add_u32 m0, s33, s51
    s_add_u32 s33, s35, 3072
    buffer_load_dwordx4 v2, s[8:11], s33 offen sc1 lds
    s_mul_i32 s33, s57, 4
    s_add_u32 m0, s33, s52
    s_add_u32 s33, s35, 4096
    buffer_load_dwordx4 v2, s[8:11], s33 offen sc1 lds
    s_add_u32 s35, s35, 20480
    s_mul_i32 s33, s53, 5
    s_add_u32 m0, s33, s48
    s_add_u32 s33, s35, 0
    buffer_load_dwordx4 v2, s[8:11], s33 offen sc1 lds
    s_mul_i32 s33, s54, 5
    s_add_u32 m0, s33, s49
    s_add_u32 s33, s35, 1024
    buffer_load_dwordx4 v2, s[8:11], s33 offen sc1 lds
    s_mul_i32 s33, s55, 5
    s_add_u32 m0, s33, s50
    s_add_u32 s33, s35, 2048
    buffer_load_dwordx4 v2, s[8:11], s33 offen sc1 lds
    s_mul_i32 s33, s56, 5
    s_add_u32 m0, s33, s51
    s_add_u32 s33, s35, 3072
    buffer_load_dwordx4 v2, s[8:11], s33 offen sc1 lds
    s_mul_i32 s33, s57, 5
    s_add_u32 m0, s33, s52
    s_add_u32 s33, s35, 4096
    buffer_load_dwordx4 v2, s[8:11], s33 offen sc1 lds
    s_add_u32 s35, s35, 20480
    s_barrier
    s_cmp_lg_u32 s23, 0
    s_cbranch_scc1 L_w4only_61
    s_mov_b32 exec_lo, 0xffff
    s_mov_b32 exec_hi, 0
    buffer_load_dword v22, v18, s[8:11], s41 offen sc1
    s_waitcnt vmcnt(0)
    s_mov_b32 exec_lo, 0xffff
    s_mov_b32 exec_hi, 0
    s_mov_b32 s59, 131072
L_poll_62:
    v_cmp_ne_u32 vcc, s18, v22
    s_nop 0
    s_and_b64 exec, exec, vcc
    s_cbranch_scc0 L_pollok_63
    s_sub_u32 s59, s59, 1
    s_cbranch_scc1 L_pollok_63
    buffer_load_dword v22, v18, s[8:11], s41 offen sc1
    s_waitcnt vmcnt(0)
    s_branch L_poll_62
L_pollok_63:
    s_mov_b64 exec, -1
L_w4only_61:
    s_waitcnt vmcnt(10)
    s_cmp_eq_u32 s23, 0
    s_cbranch_scc1 L_w4late_64
    s_add_u32 m0, s38, 143360
    s_nop 0
    buffer_load_dwordx4 v15, s[8:11], s37 offen sc1 lds
    s_add_u32 s37, s37, 32768
    s_add_u32 m0, s38, 144384
    s_nop 0
    buffer_load_dwordx4 v15, s[8:11], s37 offen sc1 lds
    s_add_u32 s37, s37, 32768
    s_add_u32 m0, s38, 145408
    s_nop 0
    buffer_load_dwordx4 v15, s[8:11], s37 offen sc1 lds
    s_add_u32 s37, s37, 32768
    s_add_u32 s33, s35, 0
    buffer_load_dwordx4 v[96:99], v2, s[8:11], s33 offen sc1
    s_add_u32 s33, s35, 1024
    buffer_load_dwordx4 v[100:103], v2, s[8:11], s33 offen sc1
    s_add_u32 s33, s35, 2048
    buffer_load_dwordx4 v[104:107], v2, s[8:11], s33 offen sc1
    s_add_u32 s33, s35, 3072
    buffer_load_dwordx4 v[108:111], v2, s[8:11], s33 offen sc1
    s_add_u32 s33, s35, 4096
    buffer_load_dwordx4 v[112:115], v2, s[8:11], s33 offen sc1
    s_add_u32 s35, s35, 20480
    s_add_u32 s33, s35, 0
    buffer_load_dwordx4 v[116:119], v2, s[8:11], s33 offen sc1
    s_add_u32 s33, s35, 1024
    buffer_load_dwordx4 v[120:123], v2, s[8:11], s33 offen sc1
    s_add_u32 s33, s35, 2048
    buffer_load_dwordx4 v[124:127], v2, s[8:11], s33 offen sc1
    s_add_u32 s33, s35, 3072
    buffer_load_dwordx4 v[128:131], v2, s[8:11], s33 offen sc1
    s_add_u32 s33, s35, 4096
    buffer_load_dwordx4 v[132:135], v2, s[8:11], s33 offen sc1
    s_add_u32 s35, s35, 20480
    s_add_u32 s33, s35, 0
    buffer_load_dwordx4 v[136:139], v2, s[8:11], s33 offen sc1
    s_add_u32 s33, s35, 1024
    buffer_load_dwordx4 v[140:143], v2, s[8:11], s33 offen sc1
    s_add_u32 s33, s35, 2048
    buffer_load_dwordx4 v[144:147], v2, s[8:11], s33 offen sc1
    s_add_u32 s33, s35, 3072
    buffer_load_dwordx4 v[148:151], v2, s[8:11], s33 offen sc1
    s_add_u32 s33, s35, 4096
    buffer_load_dwordx4 v[152:155], v2, s[8:11], s33 offen sc1
    s_add_u32 s35, s35, 20480
    s_add_u32 s33, s35, 0
    buffer_load_dwordx4 v[156:159], v2, s[8:11], s33 offen sc1
    s_add_u32 s33, s35, 1024
    buffer_load_dwordx4 v[160:163], v2, s[8:11], s33 offen sc1
    s_add_u32 s33, s35, 2048
    buffer_load_dwordx4 v[164:167], v2, s[8:11], s33 offen sc1
    s_add_u32 s33, s35, 3072
    buffer_load_dwordx4 v[168:171], v2, s[8:11], s33 offen sc1
    s_add_u32 s33, s35, 4096
    buffer_load_dwordx4 v[172:175], v2, s[8:11], s33 offen sc1
    s_add_u32 s35, s35, 20480
    s_add_u32 s33, s35, 0
    buffer_load_dwordx4 v[176:179], v2, s[8:11], s33 offen sc1
    s_add_u32 s33, s35, 1024
    buffer_load_dwordx4 v[180:183], v2, s[8:11], s33 offen sc1
    s_add_u32 s33, s35, 2048
    buffer_load_dwordx4 v[184:187], v2, s[8:11], s33 offen sc1
    s_add_u32 s33, s35, 3072
    buffer_load_dwordx4 v[188:191], v2, s[8:11], s33 offen sc1
    s_add_u32 s33, s35, 4096
    buffer_load_dwordx4 v[192:195], v2, s[8:11], s33 offen sc1
    s_barrier
    s_branch L_w4done_65
L_w4late_64:
    s_barrier
    s_add_u32 m0, s38, 143360
    s_nop 0
    buffer_load_dwordx4 v15, s[8:11], s37 offen sc1 lds
    s_add_u32 s37, s37, 32768
    s_add_u32 m0, s38, 144384
    s_nop 0
    buffer_load_dwordx4 v15, s[8:11], s37 offen sc1 lds
    s_add_u32 s37, s37, 32768
    s_add_u32 m0, s38, 145408
    s_nop 0
    buffer_load_dwordx4 v15, s[8:11], s37 offen sc1 lds
    s_add_u32 s37, s37, 32768
    s_add_u32 s33, s35, 0
    buffer_load_dwordx4 v[96:99], v2, s[8:11], s33 offen sc1
    s_add_u32 s33, s35, 1024
    buffer_load_dwordx4 v[100:103], v2, s[8:11], s33 offen sc1
    s_add_u32 s33, s35, 2048
    buffer_load_dwordx4 v[104:107], v2, s[8:11], s33 offen sc1
    s_add_u32 s33, s35, 3072
    buffer_load_dwordx4 v[108:111], v2, s[8:11], s33 offen sc1
    s_add_u32 s33, s35, 4096
    buffer_load_dwordx4 v[112:115], v2, s[8:11], s33 offen sc1
    s_add_u32 s35, s35, 20480
    s_add_u32 s33, s35, 0
    buffer_load_dwordx4 v[116:119], v2, s[8:11], s33 offen sc1
    s_add_u32 s33, s35, 1024
    buffer_load_dwordx4 v[120:123], v2, s[8:11], s33 offen sc1
    s_add_u32 s33, s35, 2048
    buffer_load_dwordx4 v[124:127], v2, s[8:11], s33 offen sc1
    s_add_u32 s33, s35, 3072
    buffer_load_dwordx4 v[128:131], v2, s[8:11], s33 offen sc1
    s_add_u32 s33, s35, 4096
    buffer_load_dwordx4 v[132:135], v2, s[8:11], s33 offen sc1
    s_add_u32 s35, s35, 20480
    s_add_u32 s33, s35, 0
    buffer_load_dwordx4 v[136:139], v2, s[8:11], s33 offen sc1
    s_add_u32 s33, s35, 1024
    buffer_load_dwordx4 v[140:143], v2, s[8:11], s33 offen sc1
    s_add_u32 s33, s35, 2048
    buffer_load_dwordx4 v[144:147], v2, s[8:11], s33 offen sc1
    s_add_u32 s33, s35, 3072
    buffer_load_dwordx4 v[148:151], v2, s[8:11], s33 offen sc1
    s_add_u32 s33, s35, 4096
    buffer_load_dwordx4 v[152:155], v2, s[8:11], s33 offen sc1
    s_add_u32 s35, s35, 20480
    s_add_u32 s33, s35, 0
    buffer_load_dwordx4 v[156:159], v2, s[8:11], s33 offen sc1
    s_add_u32 s33, s35, 1024
    buffer_load_dwordx4 v[160:163], v2, s[8:11], s33 offen sc1
    s_add_u32 s33, s35, 2048
    buffer_load_dwordx4 v[164:167], v2, s[8:11], s33 offen sc1
    s_add_u32 s33, s35, 3072
    buffer_load_dwordx4 v[168:171], v2, s[8:11], s33 offen sc1
    s_add_u32 s33, s35, 4096
    buffer_load_dwordx4 v[172:175], v2, s[8:11], s33 offen sc1
    s_add_u32 s35, s35, 20480
    s_add_u32 s33, s35, 0
    buffer_load_dwordx4 v[176:179], v2, s[8:11], s33 offen sc1
    s_add_u32 s33, s35, 1024
    buffer_load_dwordx4 v[180:183], v2, s[8:11], s33 offen sc1
    s_add_u32 s33, s35, 2048
    buffer_load_dwordx4 v[184:187], v2, s[8:11], s33 offen sc1
    s_add_u32 s33, s35, 3072
    buffer_load_dwordx4 v[188:191], v2, s[8:11], s33 offen sc1
    s_add_u32 s33, s35, 4096
    buffer_load_dwordx4 v[192:195], v2, s[8:11], s33 offen sc1
L_w4done_65:
    s_barrier
    s_barrier
    s_waitcnt vmcnt(20)
    s_mul_i32 s33, s53, 6
    s_add_u32 s33, s33, s48
    v_add_u32 v25, s33, v2
    ds_write_b128 v25, v[96:99]
    s_mul_i32 s33, s54, 6
    s_add_u32 s33, s33, s49
    v_add_u32 v26, s33, v2
    ds_write_b128 v26, v[100:103]
    s_mul_i32 s33, s55, 6
    s_add_u32 s33, s33, s50
    v_add_u32 v27, s33, v2
    ds_write_b128 v27, v[104:107]
    s_mul_i32 s33, s56, 6
    s_add_u32 s33, s33, s51
    v_add_u32 v28, s33, v2
    ds_write_b128 v28, v[108:111]
    s_barrier
    s_mul_i32 s33, s57, 6
    s_add_u32 s33, s33, s52
    v_add_u32 v25, s33, v2
    ds_write_b128 v25, v[112:115]
    s_waitcnt vmcnt(15)
    s_mul_i32 s33, s53, 0
    s_add_u32 s33, s33, s48
    v_add_u32 v26, s33, v2
    ds_write_b128 v26, v[116:119]
    s_mul_i32 s33, s54, 0
    s_add_u32 s33, s33, s49
    v_add_u32 v27, s33, v2
    ds_write_b128 v27, v[120:123]
    s_mul_i32 s33, s55, 0
    s_add_u32 s33, s33, s50
    v_add_u32 v28, s33, v2
    ds_write_b128 v28, v[124:127]
    s_barrier
    s_mul_i32 s33, s56, 0
    s_add_u32 s33, s33, s51
    v_add_u32 v25, s33, v2
    ds_write_b128 v25, v[128:131]
    s_mul_i32 s33, s57, 0
    s_add_u32 s33, s33, s52
    v_add_u32 v26, s33, v2
    ds_write_b128 v26, v[132:135]
    s_waitcnt vmcnt(10)
    s_mul_i32 s33, s53, 1
    s_add_u32 s33, s33, s48
    v_add_u32 v27, s33, v2
    ds_write_b128 v27, v[136:139]
    s_mul_i32 s33, s54, 1
    s_add_u32 s33, s33, s49
    v_add_u32 v28, s33, v2
    ds_write_b128 v28, v[140:143]
    s_barrier
    s_mul_i32 s33, s55, 1
    s_add_u32 s33, s33, s50
    v_add_u32 v25, s33, v2
    ds_write_b128 v25, v[144:147]
    s_mul_i32 s33, s56, 1
    s_add_u32 s33, s33, s51
    v_add_u32 v26, s33, v2
    ds_write_b128 v26, v[148:151]
    s_mul_i32 s33, s57, 1
    s_add_u32 s33, s33, s52
    v_add_u32 v27, s33, v2
    ds_write_b128 v27, v[152:155]
    s_waitcnt vmcnt(5)
    s_mul_i32 s33, s53, 2
    s_add_u32 s33, s33, s48
    v_add_u32 v28, s33, v2
    ds_write_b128 v28, v[156:159]
    s_barrier
    s_mul_i32 s33, s54, 2
    s_add_u32 s33, s33, s49
    v_add_u32 v25, s33, v2
    ds_write_b128 v25, v[160:163]
    s_mul_i32 s33, s55, 2
    s_add_u32 s33, s33, s50
    v_add_u32 v26, s33, v2
    ds_write_b128 v26, v[164:167]
    s_mul_i32 s33, s56, 2
    s_add_u32 s33, s33, s51
    v_add_u32 v27, s33, v2
    ds_write_b128 v27, v[168:171]
    s_mul_i32 s33, s57, 2
    s_add_u32 s33, s33, s52
    v_add_u32 v28, s33, v2
    ds_write_b128 v28, v[172:175]
    s_waitcnt lgkmcnt(15)
    s_barrier
    s_waitcnt vmcnt(0)
    s_mul_i32 s33, s53, 3
    s_add_u32 s33, s33, s48
    v_add_u32 v25, s33, v2
    ds_write_b128 v25, v[176:179]
    s_mul_i32 s33, s54, 3
    s_add_u32 s33, s33, s49
    v_add_u32 v26, s33, v2
    ds_write_b128 v26, v[180:183]
    s_mul_i32 s33, s55, 3
    s_add_u32 s33, s33, s50
    v_add_u32 v27, s33, v2
    ds_write_b128 v27, v[184:187]
    s_mul_i32 s33, s56, 3
    s_add_u32 s33, s33, s51
    v_add_u32 v28, s33, v2
    ds_write_b128 v28, v[188:191]
    s_waitcnt lgkmcnt(14)
    s_barrier
    s_mul_i32 s33, s57, 3
    s_add_u32 s33, s33, s52
    v_add_u32 v25, s33, v2
    ds_write_b128 v25, v[192:195]
    s_waitcnt lgkmcnt(10)
    s_barrier
    s_waitcnt lgkmcnt(5)
    s_barrier
    s_waitcnt lgkmcnt(0)
    s_waitcnt vmcnt(0)
    s_barrier
    s_barrier
    s_branch L_end_1
L_end_1:
L_exit_2:
    s_endpgm
code_end:
.section .rodata,"a"
.p2align 6
.amdhsa_kernel sequential_preLN__ssm_conv_s4d__swiglu_ffn__prompt_kernel
  .amdhsa_next_free_vgpr 256
  .amdhsa_next_free_sgpr 100
  .amdhsa_accum_offset 256
  .amdhsa_group_segment_fixed_size 0
  .amdhsa_kernarg_size 112
  .amdhsa_user_sgpr_count 2
  .amdhsa_user_sgpr_kernarg_segment_ptr 1
  .amdhsa_system_sgpr_workgroup_id_x 1
  .amdhsa_float_denorm_mode_32 3
  .amdhsa_float_denorm_mode_16_64 3
.end_amdhsa_kernel
```
